```python
import torch

def _softmax(x, axis=-1):
    return torch.softmax(x, dim=axis)

def _gelu(x):
    return torch.nn.functional.gelu(x, approximate='tanh')

def _silu(x):
    return torch.nn.functional.silu(x)

def _sigmoid(x):
    return torch.sigmoid(x)

def _layernorm(x, axis=-1, eps=1e-05):
    m = x.mean(dim=axis, keepdim=True)
    v = x.var(dim=axis, keepdim=True, unbiased=False)
    return (x - m) / torch.sqrt(v + eps)

def _scatter_add(tgt, idx, src, axis=0):
    return tgt.clone().index_add_(axis, idx, src)

def _segment_sum(src, seg, n):
    out = torch.zeros((n,) + src.shape[1:], dtype=src.dtype)
    return out.index_add_(0, seg, src)

def _pad(x, pw):
    flat = tuple((v for pair in reversed(pw) for v in pair))
    return torch.nn.functional.pad(x, flat)
kernel_name = 'standalone__kv_cache_quant_pre_rope_vs_post_rope__prompt'

def setup_inputs():

    _w = lambda a: (lambda t: t.to(torch.bfloat16) if t.is_floating_point() else t)(torch.as_tensor(a))
    B, Sq, Skv = (1, 2048, 2048)
    H, Dh0 = (8, 128)
    G = 32 if 32 > 0 else Dh0
    G = max(2, G // 2 * 2)
    Dh = max(G, Dh0 // G * G)
    Skv = max(Skv, Sq)
    ng = Dh // G
    bits = 8 if 8 > 1 else 4
    bits = max(2, min(8, bits))
    qmax = (1 << bits) - 1
    half = Dh // 2
    inv = 1.0 / 10000.0 ** (torch.arange(half) / max(1, half))
    ang_k = torch.arange(Skv)[:, None] * inv[None, :]
    ang_q = torch.arange(Skv - Sq, Skv)[:, None] * inv[None, :]
    kc = torch.cat([torch.cos(ang_k), torch.cos(ang_k)], dim=-1)
    ks = torch.cat([torch.sin(ang_k), torch.sin(ang_k)], dim=-1)
    qc = torch.cat([torch.cos(ang_q), torch.cos(ang_q)], dim=-1)
    qs = torch.cat([torch.sin(ang_q), torch.sin(ang_q)], dim=-1)
    qk_i = torch.randint(0, qmax + 1, (B, H, Skv, Dh)).to(torch.int32)
    qv_i = torch.randint(0, qmax + 1, (B, H, Skv, Dh)).to(torch.int32)
    ksc = torch.abs((lambda *s: torch.randn(*s, dtype=torch.bfloat16) * 0.05)(B, H, Skv, ng)) * 0.1 + 0.01
    kzp = torch.full((B, H, Skv, ng), qmax / 2.0)
    vsc = torch.abs((lambda *s: torch.randn(*s, dtype=torch.bfloat16) * 0.05)(B, H, Skv, ng)) * 0.1 + 0.01
    vzp = torch.full((B, H, Skv, ng), qmax / 2.0)
    return {'q': _w((lambda *s: torch.randn(*s, dtype=torch.bfloat16) * 0.8)(B, H, Sq, Dh) * 0.5), 'qk': _w(qk_i), 'k_scales': _w(ksc), 'k_zeros': _w(kzp), 'qv': _w(qv_i), 'v_scales': _w(vsc), 'v_zeros': _w(vzp), 'q_cos': _w(qc), 'q_sin': _w(qs), 'k_cos': _w(kc), 'k_sin': _w(ks)}

def reference(q, qk, k_scales, k_zeros, qv, v_scales, v_zeros, q_cos, q_sin, k_cos, k_sin):
    B, H, Sq, Dh = q.shape
    ng = k_scales.shape[-1]
    G = Dh // ng
    half = Dh // 2
    ks = (lambda x, n, axis: torch.repeat_interleave(x, n, dim=axis))(k_scales, G, axis=-1)
    kz = (lambda x, n, axis: torch.repeat_interleave(x, n, dim=axis))(k_zeros, G, axis=-1)
    k = ((lambda x, dt: x.to(dt))(qk, q.dtype) - kz) * ks
    vs = (lambda x, n, axis: torch.repeat_interleave(x, n, dim=axis))(v_scales, G, axis=-1)
    vz = (lambda x, n, axis: torch.repeat_interleave(x, n, dim=axis))(v_zeros, G, axis=-1)
    v = ((lambda x, dt: x.to(dt))(qv, q.dtype) - vz) * vs
    k1 = k[..., :half].clone()
    k2 = k[..., half:].clone()
    krh = torch.concatenate([-k2, k1], axis=-1)
    kr = k * k_cos[None, None, :, :] + krh * k_sin[None, None, :, :]
    q1 = q[..., :half].clone()
    q2 = q[..., half:].clone()
    qrh = torch.concatenate([-q2, q1], axis=-1)
    qr = q * q_cos[None, None, :, :] + qrh * q_sin[None, None, :, :]
    logits = torch.einsum('bhqd,bhkd->bhqk', qr, kr) * float(Dh) ** (-0.5)
    attn = _softmax(logits, axis=-1)
    out = torch.einsum('bhqk,bhkd->bhqd', attn, v)
    return out
```

```asm
; @launch grid=(256,1,1) block=(256,1,1) lds=155648
.amdgcn_target "amdgcn-amd-amdhsa--gfx950"
.text
.p2align 8
.globl standalone__kv_cache_quant_pre_rope_vs_post_rope__prompt_kernel
.type standalone__kv_cache_quant_pre_rope_vs_post_rope__prompt_kernel,@function
standalone__kv_cache_quant_pre_rope_vs_post_rope__prompt_kernel:
    s_load_dwordx16 s[4:19], s[0:1], 0
    s_cmpk_ge_u32 s2, 256
    s_cbranch_scc1 L_end
    s_getpc_b64 s[60:61]
L_pc:
    v_lshlrev_b32 v1, 6, v0
    v_min_u32 v1, L_selfprep-L_pc, v1
    global_load_dword v219, v1, s[60:61]
    v_and_b32 v217, 15, v0
    v_bfe_u32 v218, v0, 4, 2
    v_lshrrev_b32 v237, 6, v0
    v_lshlrev_b32 v236, 4, v217
    v_lshl_add_u32 v220, v218, 9, v236
    v_lshl_add_u32 v220, v237, 13, v220
    s_and_b32 s46, s2, 7
    s_lshr_b32 s47, s2, 3
    s_lshl_b32 s52, s46, 5
    s_add_u32 s52, s52, s47
    s_lshl_b32 s52, s52, 15
    s_addk_i32 s52, 0x1000
    v_add_u32 v220, s52, v220
    v_and_b32 v216, 63, v0
    s_waitcnt lgkmcnt(0)
    global_load_dwordx4 v[0:3], v220, s[6:7] offset:-4096 nt
    global_load_dwordx4 v[4:7], v220, s[6:7] offset:-3840 nt
    global_load_dwordx4 v[8:11], v220, s[6:7] offset:-2048 nt
    global_load_dwordx4 v[12:15], v220, s[6:7] offset:-1792 nt
    global_load_dwordx4 v[16:19], v220, s[6:7] offset:0 nt
    global_load_dwordx4 v[20:23], v220, s[6:7] offset:256 nt
    global_load_dwordx4 v[24:27], v220, s[6:7] offset:2048 nt
    global_load_dwordx4 v[28:31], v220, s[6:7] offset:2304 nt
    s_load_dwordx8 s[20:27], s[0:1], 64
    s_load_dwordx4 s[28:31], s[0:1], 96
    s_memrealtime s[56:57]
    v_readfirstlane_b32 s42, v237
    s_getreg_b32 s51, hwreg(HW_REG_XCC_ID, 0, 4)
    v_lshlrev_b32 v212, 4, v216
    v_add_u32 v213, 0x1000, v212
    v_add_u32 v214, 0x2000, v212
    v_add_u32 v215, 0x3000, v212
    s_lshl_b32 s51, s51, 23
    s_lshl_b32 s48, s47, 2
    s_add_u32 s48, s48, s42
    s_lshl_b32 s52, s46, 7
    s_add_u32 s52, s52, s48
    s_lshl_b32 s53, s52, 7
    v_lshl_add_u32 v222, v216, 1, s53
    s_lshr_b32 s53, s52, 1
    s_and_b32 s54, s52, 1
    s_lshl_b32 s52, s53, 14
    v_lshl_add_u32 v223, v218, 11, v236
    v_add_u32 v223, s52, v223
    s_lshl_b32 s40, s54, 8
    v_add_u32 v223, s40, v223
    v_add_u32 v224, 0x2000, v223
    s_andn2_b32 s55, s53, 63
    s_bfe_u32 s52, s53, 0x40002
    s_or_b32 s55, s55, s52
    s_and_b32 s52, s53, 3
    s_lshl4_add_u32 s55, s52, s55
    s_lshl_b32 s52, s55, 14
    s_lshl_b32 s40, s54, 12
    s_add_u32 s52, s52, s40
    v_add_u32 v226, s52, v213
    s_lshl_b32 s53, s53, 8
    s_lshl_b32 s54, s54, 2
    s_add_u32 s53, s53, s54
    v_and_b32 v237, 31, v216
    v_lshrrev_b32 v238, 5, v216
    v_lshlrev_b32 v238, 1, v238
    v_lshl_add_u32 v225, v237, 3, v238
    v_add_u32 v225, s53, v225
    s_lshl_b32 s53, s48, 12
    v_lshlrev_b32 v221, 3, v217
    v_lshl_add_u32 v221, v218, 8, v221
    v_add_u32 v221, s53, v221
    s_lshl_b32 s52, s46, 19
    v_add_u32 v233, s52, v221
    s_lshr_b32 s52, s51, 10
    s_lshl_b32 s53, s46, 10
    s_add_u32 s52, s52, s53
    s_add_u32 s52, s52, 0x800000
    s_and_b32 s53, s55, 63
    s_and_b32 s54, s42, 1
    s_lshl1_add_u32 s53, s53, s54
    s_lshl3_add_u32 s53, s53, s52
    v_mov_b32 v240, s53
    s_bfe_u32 s100, s55, 0x20004
    s_lshl_b32 s53, s100, 8
    s_add_u32 s53, s53, s52
    v_and_b32 v235, 31, v216
    v_lshl_add_u32 v235, v235, 3, s53
    v_mov_b32 v252, 116736
    v_mov_b32 v253, 0
    ds_write2_b32 v252, v253, v253 offset0:0 offset1:1
    ds_write2_b32 v252, v253, v253 offset0:2 offset1:3
    ds_write2_b32 v252, v253, v253 offset0:4 offset1:5
    global_load_ushort v144, v222, s[8:9] nt
    global_load_ushort v145, v222, s[10:11] nt
    global_load_ushort v146, v225, s[14:15] nt
    global_load_ushort v147, v225, s[16:17] nt
    s_mov_b32 s49, 0xffff0000
    s_mov_b32 s50, 0x3e0293ee
    s_mov_b32 s62, 0x3e22f983
    s_mov_b32 s63, 0x31dc9c88
    s_mov_b32 exec_lo, 0x00010001
    s_mov_b32 exec_hi, 0x00010001
    v_mov_b32 v242, 0x3f800000
    v_mov_b32 v243, 0x3f5dafd7
    v_mov_b32 v244, 0x3f3ff911
    v_mov_b32 v245, 0x3f263de0
    s_lshl_b64 exec, exec, 1
    v_mov_b32 v242, 0x3f0ff59a
    v_mov_b32 v243, 0x3ef953cf
    v_mov_b32 v244, 0x3ed7e89b
    v_mov_b32 v245, 0x3ebaf81b
    s_lshl_b64 exec, exec, 1
    v_mov_b32 v242, 0x3ea1e89b
    v_mov_b32 v243, 0x3e8c3504
    v_mov_b32 v244, 0x3e72d423
    v_mov_b32 v245, 0x3e5247ed
    s_lshl_b64 exec, exec, 1
    v_mov_b32 v242, 0x3e361887
    v_mov_b32 v243, 0x3e1db040
    v_mov_b32 v244, 0x3e088d77
    v_mov_b32 v245, 0x3dec7fd6
    s_lshl_b64 exec, exec, 1
    v_mov_b32 v242, 0x3dcccccd
    v_mov_b32 v243, 0x3db15978
    v_mov_b32 v244, 0x3d99940d
    v_mov_b32 v245, 0x3d84fe4d
    s_lshl_b64 exec, exec, 1
    v_mov_b32 v242, 0x3d6655c2
    v_mov_b32 v243, 0x3d47763f
    v_mov_b32 v244, 0x3d2cba15
    v_mov_b32 v245, 0x3d159348
    s_lshl_b64 exec, exec, 1
    v_mov_b32 v242, 0x3d0186e3
    v_mov_b32 v243, 0x3ce054d2
    v_mov_b32 v244, 0x3cc2434f
    v_mov_b32 v245, 0x3ca8398b
    s_lshl_b64 exec, exec, 1
    v_mov_b32 v242, 0x3c91ad39
    v_mov_b32 v243, 0x3c7c4d33
    v_mov_b32 v244, 0x3c5a7bf2
    v_mov_b32 v245, 0x3c3d3311
    s_lshl_b64 exec, exec, 1
    v_mov_b32 v242, 0x3c23d70a
    v_mov_b32 v243, 0x3c0de12d
    v_mov_b32 v244, 0x3bf5b9b0
    v_mov_b32 v245, 0x3bd4ca15
    s_lshl_b64 exec, exec, 1
    v_mov_b32 v242, 0x3bb8449c
    v_mov_b32 v243, 0x3b9f91cc
    v_mov_b32 v244, 0x3b8a2e77
    v_mov_b32 v245, 0x3b6f520e
    s_lshl_b64 exec, exec, 1
    v_mov_b32 v242, 0x3b4f3e38
    v_mov_b32 v243, 0x3b33770f
    v_mov_b32 v244, 0x3b1b690d
    v_mov_b32 v245, 0x3b06946f
    s_lshl_b64 exec, exec, 1
    v_mov_b32 v242, 0x3ae91528
    v_mov_b32 v243, 0x3ac9d75c
    v_mov_b32 v244, 0x3aaec98e
    v_mov_b32 v245, 0x3a975c0e
    s_lshl_b64 exec, exec, 1
    v_mov_b32 v242, 0x3a83126f
    v_mov_b32 v243, 0x3a6301e2
    v_mov_b32 v244, 0x3a44948c
    v_mov_b32 v245, 0x3a2a3b44
    s_lshl_b64 exec, exec, 1
    v_mov_b32 v242, 0x3a136a16
    v_mov_b32 v243, 0x39ff4fac
    v_mov_b32 v244, 0x39dd1725
    v_mov_b32 v245, 0x39bf74d7
    s_lshl_b64 exec, exec, 1
    v_mov_b32 v242, 0x39a5cb60
    v_mov_b32 v243, 0x398f9272
    v_mov_b32 v244, 0x3978a815
    v_mov_b32 v245, 0x395753e4
    s_lshl_b64 exec, exec, 1
    v_mov_b32 v242, 0x393a7753
    v_mov_b32 v243, 0x39217916
    v_mov_b32 v244, 0x390bd472
    v_mov_b32 v245, 0x38f22ce2
    s_mov_b64 exec, -1
    s_lshl_b32 s52, s48, 4
    v_add_u32 v180, s52, v218
    v_cvt_f32_u32 v180, v180
    v_mul_f32 v181, v180, v242
    v_mul_f32 v182, v180, v243
    v_mul_f32 v183, v180, v244
    v_mul_f32 v184, v180, v245
    v_mul_f32 v32, s62, v181
    v_mul_f32 v33, s62, v182
    v_mul_f32 v34, s62, v183
    v_mul_f32 v35, s62, v184
    v_fma_f32 v48, v181, s62, -v32
    v_fma_f32 v49, v182, s62, -v33
    v_fma_f32 v50, v183, s62, -v34
    v_fma_f32 v51, v184, s62, -v35
    v_fma_f32 v48, v181, s63, v48
    v_fma_f32 v49, v182, s63, v49
    v_fma_f32 v50, v183, s63, v50
    v_fma_f32 v51, v184, s63, v51
    v_fract_f32 v32, v32
    v_fract_f32 v33, v33
    v_fract_f32 v34, v34
    v_fract_f32 v35, v35
    v_add_f32 v181, v32, v48
    v_add_f32 v182, v33, v49
    v_add_f32 v183, v34, v50
    v_add_f32 v184, v35, v51
    v_cos_f32 v32, v181
    v_sin_f32 v48, v181
    v_cos_f32 v33, v182
    v_sin_f32 v49, v182
    v_cos_f32 v34, v183
    v_sin_f32 v50, v183
    v_cos_f32 v35, v184
    v_sin_f32 v51, v184
    v_add_f32 v180, 4.0, v180
    v_cvt_pk_bf16_f32 v48, v32, v48
    v_cvt_pk_bf16_f32 v49, v33, v49
    v_cvt_pk_bf16_f32 v50, v34, v50
    v_cvt_pk_bf16_f32 v51, v35, v51
    v_lshlrev_b32 v32, 16, v48
    v_and_b32 v48, s49, v48
    v_lshlrev_b32 v33, 16, v49
    v_and_b32 v49, s49, v49
    v_lshlrev_b32 v34, 16, v50
    v_and_b32 v50, s49, v50
    v_lshlrev_b32 v35, 16, v51
    v_and_b32 v51, s49, v51
    v_mul_f32 v181, v180, v242
    v_mul_f32 v182, v180, v243
    v_mul_f32 v183, v180, v244
    v_mul_f32 v184, v180, v245
    v_mul_f32 v36, s62, v181
    v_mul_f32 v37, s62, v182
    v_mul_f32 v38, s62, v183
    v_mul_f32 v39, s62, v184
    v_fma_f32 v52, v181, s62, -v36
    v_fma_f32 v53, v182, s62, -v37
    v_fma_f32 v54, v183, s62, -v38
    v_fma_f32 v55, v184, s62, -v39
    v_fma_f32 v52, v181, s63, v52
    v_fma_f32 v53, v182, s63, v53
    v_fma_f32 v54, v183, s63, v54
    v_fma_f32 v55, v184, s63, v55
    v_fract_f32 v36, v36
    v_fract_f32 v37, v37
    v_fract_f32 v38, v38
    v_fract_f32 v39, v39
    v_add_f32 v181, v36, v52
    v_add_f32 v182, v37, v53
    v_add_f32 v183, v38, v54
    v_add_f32 v184, v39, v55
    v_cos_f32 v36, v181
    v_sin_f32 v52, v181
    v_cos_f32 v37, v182
    v_sin_f32 v53, v182
    v_cos_f32 v38, v183
    v_sin_f32 v54, v183
    v_cos_f32 v39, v184
    v_sin_f32 v55, v184
    v_add_f32 v180, 4.0, v180
    v_cvt_pk_bf16_f32 v52, v36, v52
    v_cvt_pk_bf16_f32 v53, v37, v53
    v_cvt_pk_bf16_f32 v54, v38, v54
    v_cvt_pk_bf16_f32 v55, v39, v55
    v_lshlrev_b32 v36, 16, v52
    v_and_b32 v52, s49, v52
    v_lshlrev_b32 v37, 16, v53
    v_and_b32 v53, s49, v53
    v_lshlrev_b32 v38, 16, v54
    v_and_b32 v54, s49, v54
    v_lshlrev_b32 v39, 16, v55
    v_and_b32 v55, s49, v55
    v_mul_f32 v181, v180, v242
    v_mul_f32 v182, v180, v243
    v_mul_f32 v183, v180, v244
    v_mul_f32 v184, v180, v245
    v_mul_f32 v40, s62, v181
    v_mul_f32 v41, s62, v182
    v_mul_f32 v42, s62, v183
    v_mul_f32 v43, s62, v184
    v_fma_f32 v56, v181, s62, -v40
    v_fma_f32 v57, v182, s62, -v41
    v_fma_f32 v58, v183, s62, -v42
    v_fma_f32 v59, v184, s62, -v43
    v_fma_f32 v56, v181, s63, v56
    v_fma_f32 v57, v182, s63, v57
    v_fma_f32 v58, v183, s63, v58
    v_fma_f32 v59, v184, s63, v59
    v_fract_f32 v40, v40
    v_fract_f32 v41, v41
    v_fract_f32 v42, v42
    v_fract_f32 v43, v43
    v_add_f32 v181, v40, v56
    v_add_f32 v182, v41, v57
    v_add_f32 v183, v42, v58
    v_add_f32 v184, v43, v59
    v_cos_f32 v40, v181
    v_sin_f32 v56, v181
    v_cos_f32 v41, v182
    v_sin_f32 v57, v182
    v_cos_f32 v42, v183
    v_sin_f32 v58, v183
    v_cos_f32 v43, v184
    v_sin_f32 v59, v184
    v_add_f32 v180, 4.0, v180
    v_cvt_pk_bf16_f32 v56, v40, v56
    v_cvt_pk_bf16_f32 v57, v41, v57
    v_cvt_pk_bf16_f32 v58, v42, v58
    v_cvt_pk_bf16_f32 v59, v43, v59
    v_lshlrev_b32 v40, 16, v56
    v_and_b32 v56, s49, v56
    v_lshlrev_b32 v41, 16, v57
    v_and_b32 v57, s49, v57
    v_lshlrev_b32 v42, 16, v58
    v_and_b32 v58, s49, v58
    v_lshlrev_b32 v43, 16, v59
    v_and_b32 v59, s49, v59
    v_mul_f32 v181, v180, v242
    v_mul_f32 v182, v180, v243
    v_mul_f32 v183, v180, v244
    v_mul_f32 v184, v180, v245
    v_mul_f32 v44, s62, v181
    v_mul_f32 v45, s62, v182
    v_mul_f32 v46, s62, v183
    v_mul_f32 v47, s62, v184
    v_fma_f32 v60, v181, s62, -v44
    v_fma_f32 v61, v182, s62, -v45
    v_fma_f32 v62, v183, s62, -v46
    v_fma_f32 v63, v184, s62, -v47
    v_fma_f32 v60, v181, s63, v60
    v_fma_f32 v61, v182, s63, v61
    v_fma_f32 v62, v183, s63, v62
    v_fma_f32 v63, v184, s63, v63
    v_fract_f32 v44, v44
    v_fract_f32 v45, v45
    v_fract_f32 v46, v46
    v_fract_f32 v47, v47
    v_add_f32 v181, v44, v60
    v_add_f32 v182, v45, v61
    v_add_f32 v183, v46, v62
    v_add_f32 v184, v47, v63
    v_cos_f32 v44, v181
    v_sin_f32 v60, v181
    v_cos_f32 v45, v182
    v_sin_f32 v61, v182
    v_cos_f32 v46, v183
    v_sin_f32 v62, v183
    v_cos_f32 v47, v184
    v_sin_f32 v63, v184
    s_nop 0
    v_cvt_pk_bf16_f32 v60, v44, v60
    v_cvt_pk_bf16_f32 v61, v45, v61
    v_cvt_pk_bf16_f32 v62, v46, v62
    v_cvt_pk_bf16_f32 v63, v47, v63
    v_lshlrev_b32 v44, 16, v60
    v_and_b32 v60, s49, v60
    v_lshlrev_b32 v45, 16, v61
    v_and_b32 v61, s49, v61
    v_lshlrev_b32 v46, 16, v62
    v_and_b32 v62, s49, v62
    v_lshlrev_b32 v47, 16, v63
    v_and_b32 v63, s49, v63
    s_waitcnt lgkmcnt(0)
    s_barrier
    global_load_dwordx2 v[96:97], v233, s[4:5] offset:0 nt
    global_load_dwordx2 v[98:99], v233, s[4:5] offset:128 nt
    global_load_dwordx2 v[100:101], v233, s[4:5] offset:1024 nt
    global_load_dwordx2 v[102:103], v233, s[4:5] offset:1152 nt
    global_load_dwordx2 v[104:105], v233, s[4:5] offset:2048 nt
    global_load_dwordx2 v[106:107], v233, s[4:5] offset:2176 nt
    global_load_dwordx2 v[108:109], v233, s[4:5] offset:3072 nt
    global_load_dwordx2 v[110:111], v233, s[4:5] offset:3200 nt
    global_load_dwordx4 v[64:67], v223, s[12:13] offset:0 nt
    global_load_dwordx4 v[68:71], v223, s[12:13] offset:512 nt
    global_load_dwordx4 v[72:75], v223, s[12:13] offset:1024 nt
    global_load_dwordx4 v[76:79], v223, s[12:13] offset:1536 nt
    global_load_dwordx4 v[80:83], v224, s[12:13] offset:0 nt
    global_load_dwordx4 v[84:87], v224, s[12:13] offset:512 nt
    global_load_dwordx4 v[88:91], v224, s[12:13] offset:1024 nt
    global_load_dwordx4 v[92:95], v224, s[12:13] offset:1536 nt
    s_waitcnt lgkmcnt(0)
    v_mul_f32 v112, s50, v32
    v_mul_f32 v113, s50, v33
    v_mul_f32 v114, s50, v34
    v_mul_f32 v115, s50, v35
    v_mul_f32 v116, s50, v36
    v_mul_f32 v117, s50, v37
    v_mul_f32 v118, s50, v38
    v_mul_f32 v119, s50, v39
    v_mul_f32 v120, s50, v40
    v_mul_f32 v121, s50, v41
    v_mul_f32 v122, s50, v42
    v_mul_f32 v123, s50, v43
    v_mul_f32 v124, s50, v44
    v_mul_f32 v125, s50, v45
    v_mul_f32 v126, s50, v46
    v_mul_f32 v127, s50, v47
    v_mul_f32 v128, s50, v48
    v_mul_f32 v129, s50, v49
    v_mul_f32 v130, s50, v50
    v_mul_f32 v131, s50, v51
    v_mul_f32 v132, s50, v52
    v_mul_f32 v133, s50, v53
    v_mul_f32 v134, s50, v54
    v_mul_f32 v135, s50, v55
    v_mul_f32 v136, s50, v56
    v_mul_f32 v137, s50, v57
    v_mul_f32 v138, s50, v58
    v_mul_f32 v139, s50, v59
    v_mul_f32 v140, s50, v60
    v_mul_f32 v141, s50, v61
    v_mul_f32 v142, s50, v62
    v_mul_f32 v143, s50, v63
    s_mul_i32 s52, s42, 5376
    s_add_u32 s52, s52, 117760
    v_mul_u32_u24 v236, 272, v217
    v_lshl_add_u32 v236, v218, 4, v236
    v_add_u32 v227, s52, v236
    s_mul_i32 s53, s42, 4352
    s_add_u32 s53, s53, 98304
    v_add_u32 v234, s53, v236
    v_mul_u32_u24 v236, 272, v218
    v_lshl_add_u32 v239, v217, 4, v236
    v_add_u32 v228, s52, v239
    v_lshrrev_b32 v236, 2, v216
    v_lshlrev_b32 v236, 5, v236
    v_and_b32 v237, 1, v216
    v_lshl_add_u32 v236, v237, 4, v236
    v_and_b32 v237, 2, v216
    v_lshl_add_u32 v236, v237, 2, v236
    v_add_u32 v229, s52, v236
    v_lshrrev_b32 v237, 3, v217
    v_lshlrev_b32 v236, 4, v237
    v_lshl_add_u32 v236, v218, 5, v236
    v_add_u32 v230, s52, v236
    v_lshl_add_u32 v231, v216, 2, s52
    v_lshlrev_b32 v236, 7, v237
    v_lshl_add_u32 v236, v218, 4, v236
    v_add_u32 v232, s52, v236
    global_load_dword v219, v235, s[30:31] sc1
    s_mov_b32 s34, 0x40000
    s_mov_b32 s35, 0x20000
    s_mov_b32 s41, 0
    s_andn2_b32 s53, s47, 1
    s_lshl_b32 s28, 1, s53
    s_mov_b32 s29, s28
    s_lshr_b32 s52, s42, 1
    s_lshl_b32 s53, s52, 13
    s_add_u32 s53, s53, 139264
    v_add_u32 v254, s53, v212
    s_lshl3_add_u32 s52, s52, 116744
    v_mov_b32 v255, s52
    s_and_b32 s25, s47, 1
    s_lshl_b32 s25, s25, 1
    v_mov_b32 v250, s56
    v_mov_b32 v251, s57
    s_add_u32 s58, s56, 0x1000000
    s_addc_u32 s59, s57, 0
    s_sub_u32 s56, s56, 400
    s_subb_u32 s57, s57, 0
    s_mov_b64 s[22:23], 0
    s_mov_b32 s44, 0x55555555
    s_mov_b32 s45, 0
    s_lshl_b64 s[44:45], s[44:45], s25
    v_cmp_eq_u32 vcc, 0, v217
    v_mov_b32 v236, 0x3f803f80
    v_mov_b32 v246, 0
    v_mov_b32 v247, 0
    v_mov_b32 v248, 0
    v_mov_b32 v249, 0
    v_cndmask_b32 v208, 0, v236, vcc
    v_cndmask_b32 v209, 0, v236, vcc
    v_cndmask_b32 v210, 0, v236, vcc
    v_cndmask_b32 v211, 0, v236, vcc
    s_waitcnt vmcnt(17)
    v_lshlrev_b32 v144, 16, v144
    v_lshlrev_b32 v145, 16, v145
    v_lshlrev_b32 v146, 16, v146
    v_lshlrev_b32 v147, 16, v147
    v_mul_f32 v145, v145, v144
    v_mul_f32 v147, v147, v146
    ds_write_b64 v229, v[144:145] offset:4352
    ds_write_b32 v231, v146 offset:4864
    ds_write_b32 v231, v147 offset:5120
    v_cvt_f32_i32 v0, v0
    v_cvt_f32_i32 v1, v1
    v_cvt_f32_i32 v2, v2
    v_cvt_f32_i32 v3, v3
    v_cvt_f32_i32 v4, v4
    v_cvt_f32_i32 v5, v5
    v_cvt_f32_i32 v6, v6
    v_cvt_f32_i32 v7, v7
    v_cvt_f32_i32 v8, v8
    v_cvt_f32_i32 v9, v9
    v_cvt_f32_i32 v10, v10
    v_cvt_f32_i32 v11, v11
    s_waitcnt lgkmcnt(0)
    ds_read_b128 v[148:151], v230 offset:4352
    ds_read_b128 v[152:155], v230 offset:4480
    ds_read_b128 v[156:159], v230 offset:4608
    ds_read_b128 v[160:163], v230 offset:4736
    ds_read_b128 v[164:167], v232 offset:4864
    ds_read_b128 v[168:171], v232 offset:4928
    ds_read_b128 v[172:175], v232 offset:5120
    ds_read_b128 v[176:179], v232 offset:5184
    v_cvt_f32_i32 v12, v12
    v_cvt_f32_i32 v13, v13
    v_cvt_f32_i32 v14, v14
    v_cvt_f32_i32 v15, v15
    v_cvt_f32_i32 v16, v16
    v_cvt_f32_i32 v17, v17
    v_cvt_f32_i32 v18, v18
    v_cvt_f32_i32 v19, v19
    v_cvt_f32_i32 v20, v20
    v_cvt_f32_i32 v21, v21
    v_cvt_f32_i32 v22, v22
    v_cvt_f32_i32 v23, v23
    v_cvt_f32_i32 v24, v24
    v_cvt_f32_i32 v25, v25
    v_cvt_f32_i32 v26, v26
    v_cvt_f32_i32 v27, v27
    v_cvt_f32_i32 v28, v28
    v_cvt_f32_i32 v29, v29
    v_cvt_f32_i32 v30, v30
    v_cvt_f32_i32 v31, v31
    s_waitcnt lgkmcnt(0)
    v_fma_f32 v0, v0, v148, -v149
    v_fma_f32 v1, v1, v148, -v149
    v_fma_f32 v2, v2, v148, -v149
    v_fma_f32 v3, v3, v148, -v149
    v_fma_f32 v4, v4, v150, -v151
    v_fma_f32 v5, v5, v150, -v151
    v_fma_f32 v6, v6, v150, -v151
    v_fma_f32 v7, v7, v150, -v151
    v_mul_f32 v180, v0, v32
    v_mul_f32 v184, v4, v32
    v_mul_f32 v181, v1, v33
    v_mul_f32 v185, v5, v33
    v_mul_f32 v182, v2, v34
    v_mul_f32 v186, v6, v34
    v_mul_f32 v183, v3, v35
    v_mul_f32 v187, v7, v35
    v_fma_f32 v180, -v4, v48, v180
    v_fma_f32 v184, v0, v48, v184
    v_fma_f32 v181, -v5, v49, v181
    v_fma_f32 v185, v1, v49, v185
    v_fma_f32 v182, -v6, v50, v182
    v_fma_f32 v186, v2, v50, v186
    v_fma_f32 v183, -v7, v51, v183
    v_fma_f32 v187, v3, v51, v187
    v_cvt_pk_bf16_f32 v188, v180, v181
    v_cvt_pk_bf16_f32 v189, v182, v183
    v_cvt_pk_bf16_f32 v190, v184, v185
    v_cvt_pk_bf16_f32 v191, v186, v187
    ds_write_b128 v227, v[188:191] offset:0
    v_fma_f32 v8, v8, v152, -v153
    v_fma_f32 v9, v9, v152, -v153
    v_fma_f32 v10, v10, v152, -v153
    v_fma_f32 v11, v11, v152, -v153
    v_fma_f32 v12, v12, v154, -v155
    v_fma_f32 v13, v13, v154, -v155
    v_fma_f32 v14, v14, v154, -v155
    v_fma_f32 v15, v15, v154, -v155
    v_mul_f32 v180, v8, v36
    v_mul_f32 v184, v12, v36
    v_mul_f32 v181, v9, v37
    v_mul_f32 v185, v13, v37
    v_mul_f32 v182, v10, v38
    v_mul_f32 v186, v14, v38
    v_mul_f32 v183, v11, v39
    v_mul_f32 v187, v15, v39
    v_fma_f32 v180, -v12, v52, v180
    v_fma_f32 v184, v8, v52, v184
    v_fma_f32 v181, -v13, v53, v181
    v_fma_f32 v185, v9, v53, v185
    v_fma_f32 v182, -v14, v54, v182
    v_fma_f32 v186, v10, v54, v186
    v_fma_f32 v183, -v15, v55, v183
    v_fma_f32 v187, v11, v55, v187
    v_cvt_pk_bf16_f32 v192, v180, v181
    v_cvt_pk_bf16_f32 v193, v182, v183
    v_cvt_pk_bf16_f32 v194, v184, v185
    v_cvt_pk_bf16_f32 v195, v186, v187
    ds_write_b128 v227, v[192:195] offset:64
    v_fma_f32 v16, v16, v156, -v157
    v_fma_f32 v17, v17, v156, -v157
    v_fma_f32 v18, v18, v156, -v157
    v_fma_f32 v19, v19, v156, -v157
    v_fma_f32 v20, v20, v158, -v159
    v_fma_f32 v21, v21, v158, -v159
    v_fma_f32 v22, v22, v158, -v159
    v_fma_f32 v23, v23, v158, -v159
    v_mul_f32 v180, v16, v40
    v_mul_f32 v184, v20, v40
    v_mul_f32 v181, v17, v41
    v_mul_f32 v185, v21, v41
    v_mul_f32 v182, v18, v42
    v_mul_f32 v186, v22, v42
    v_mul_f32 v183, v19, v43
    v_mul_f32 v187, v23, v43
    v_fma_f32 v180, -v20, v56, v180
    v_fma_f32 v184, v16, v56, v184
    v_fma_f32 v181, -v21, v57, v181
    v_fma_f32 v185, v17, v57, v185
    v_fma_f32 v182, -v22, v58, v182
    v_fma_f32 v186, v18, v58, v186
    v_fma_f32 v183, -v23, v59, v183
    v_fma_f32 v187, v19, v59, v187
    v_cvt_pk_bf16_f32 v196, v180, v181
    v_cvt_pk_bf16_f32 v197, v182, v183
    v_cvt_pk_bf16_f32 v198, v184, v185
    v_cvt_pk_bf16_f32 v199, v186, v187
    ds_write_b128 v227, v[196:199] offset:128
    v_fma_f32 v24, v24, v160, -v161
    v_fma_f32 v25, v25, v160, -v161
    v_fma_f32 v26, v26, v160, -v161
    v_fma_f32 v27, v27, v160, -v161
    v_fma_f32 v28, v28, v162, -v163
    v_fma_f32 v29, v29, v162, -v163
    v_fma_f32 v30, v30, v162, -v163
    v_fma_f32 v31, v31, v162, -v163
    v_mul_f32 v180, v24, v44
    v_mul_f32 v184, v28, v44
    v_mul_f32 v181, v25, v45
    v_mul_f32 v185, v29, v45
    v_mul_f32 v182, v26, v46
    v_mul_f32 v186, v30, v46
    v_mul_f32 v183, v27, v47
    v_mul_f32 v187, v31, v47
    v_fma_f32 v180, -v28, v60, v180
    v_fma_f32 v184, v24, v60, v184
    v_fma_f32 v181, -v29, v61, v181
    v_fma_f32 v185, v25, v61, v185
    v_fma_f32 v182, -v30, v62, v182
    v_fma_f32 v186, v26, v62, v186
    v_fma_f32 v183, -v31, v63, v183
    v_fma_f32 v187, v27, v63, v187
    v_cvt_pk_bf16_f32 v200, v180, v181
    v_cvt_pk_bf16_f32 v201, v182, v183
    v_cvt_pk_bf16_f32 v202, v184, v185
    v_cvt_pk_bf16_f32 v203, v186, v187
    ds_write_b128 v227, v[200:203] offset:192
    s_waitcnt lgkmcnt(0)
    ds_read_b128 v[0:3], v228 offset:0
    ds_read_b128 v[4:7], v228 offset:1088
    ds_read_b128 v[8:11], v228 offset:2176
    ds_read_b128 v[12:15], v228 offset:3264
    s_waitcnt vmcnt(9)
    v_lshlrev_b32 v148, 16, v96
    v_lshlrev_b32 v152, 16, v98
    v_and_b32 v149, s49, v96
    v_and_b32 v153, s49, v98
    v_lshlrev_b32 v150, 16, v97
    v_lshlrev_b32 v154, 16, v99
    v_and_b32 v151, s49, v97
    v_and_b32 v155, s49, v99
    v_mul_f32 v180, v148, v112
    v_mul_f32 v184, v152, v112
    v_mul_f32 v181, v149, v113
    v_mul_f32 v185, v153, v113
    v_mul_f32 v182, v150, v114
    v_mul_f32 v186, v154, v114
    v_mul_f32 v183, v151, v115
    v_mul_f32 v187, v155, v115
    v_fma_f32 v180, -v152, v128, v180
    v_fma_f32 v184, v148, v128, v184
    v_fma_f32 v181, -v153, v129, v181
    v_fma_f32 v185, v149, v129, v185
    v_fma_f32 v182, -v154, v130, v182
    v_fma_f32 v186, v150, v130, v186
    v_fma_f32 v183, -v155, v131, v183
    v_fma_f32 v187, v151, v131, v187
    v_cvt_pk_bf16_f32 v188, v180, v181
    v_cvt_pk_bf16_f32 v189, v182, v183
    v_cvt_pk_bf16_f32 v190, v184, v185
    v_cvt_pk_bf16_f32 v191, v186, v187
    ds_write_b128 v234, v[188:191] offset:0
    v_lshlrev_b32 v148, 16, v100
    v_lshlrev_b32 v152, 16, v102
    v_and_b32 v149, s49, v100
    v_and_b32 v153, s49, v102
    v_lshlrev_b32 v150, 16, v101
    v_lshlrev_b32 v154, 16, v103
    v_and_b32 v151, s49, v101
    v_and_b32 v155, s49, v103
    v_mul_f32 v180, v148, v116
    v_mul_f32 v184, v152, v116
    v_mul_f32 v181, v149, v117
    v_mul_f32 v185, v153, v117
    v_mul_f32 v182, v150, v118
    v_mul_f32 v186, v154, v118
    v_mul_f32 v183, v151, v119
    v_mul_f32 v187, v155, v119
    v_fma_f32 v180, -v152, v132, v180
    v_fma_f32 v184, v148, v132, v184
    v_fma_f32 v181, -v153, v133, v181
    v_fma_f32 v185, v149, v133, v185
    v_fma_f32 v182, -v154, v134, v182
    v_fma_f32 v186, v150, v134, v186
    v_fma_f32 v183, -v155, v135, v183
    v_fma_f32 v187, v151, v135, v187
    v_cvt_pk_bf16_f32 v192, v180, v181
    v_cvt_pk_bf16_f32 v193, v182, v183
    v_cvt_pk_bf16_f32 v194, v184, v185
    v_cvt_pk_bf16_f32 v195, v186, v187
    ds_write_b128 v234, v[192:195] offset:64
    v_lshlrev_b32 v148, 16, v104
    v_lshlrev_b32 v152, 16, v106
    v_and_b32 v149, s49, v104
    v_and_b32 v153, s49, v106
    v_lshlrev_b32 v150, 16, v105
    v_lshlrev_b32 v154, 16, v107
    v_and_b32 v151, s49, v105
    v_and_b32 v155, s49, v107
    v_mul_f32 v180, v148, v120
    v_mul_f32 v184, v152, v120
    v_mul_f32 v181, v149, v121
    v_mul_f32 v185, v153, v121
    v_mul_f32 v182, v150, v122
    v_mul_f32 v186, v154, v122
    v_mul_f32 v183, v151, v123
    v_mul_f32 v187, v155, v123
    v_fma_f32 v180, -v152, v136, v180
    v_fma_f32 v184, v148, v136, v184
    v_fma_f32 v181, -v153, v137, v181
    v_fma_f32 v185, v149, v137, v185
    v_fma_f32 v182, -v154, v138, v182
    v_fma_f32 v186, v150, v138, v186
    v_fma_f32 v183, -v155, v139, v183
    v_fma_f32 v187, v151, v139, v187
    v_cvt_pk_bf16_f32 v196, v180, v181
    v_cvt_pk_bf16_f32 v197, v182, v183
    v_cvt_pk_bf16_f32 v198, v184, v185
    v_cvt_pk_bf16_f32 v199, v186, v187
    ds_write_b128 v234, v[196:199] offset:128
    v_lshlrev_b32 v148, 16, v108
    v_lshlrev_b32 v152, 16, v110
    v_and_b32 v149, s49, v108
    v_and_b32 v153, s49, v110
    v_lshlrev_b32 v150, 16, v109
    v_lshlrev_b32 v154, 16, v111
    v_and_b32 v151, s49, v109
    v_and_b32 v155, s49, v111
    v_mul_f32 v180, v148, v124
    v_mul_f32 v184, v152, v124
    v_mul_f32 v181, v149, v125
    v_mul_f32 v185, v153, v125
    v_mul_f32 v182, v150, v126
    v_mul_f32 v186, v154, v126
    v_mul_f32 v183, v151, v127
    v_mul_f32 v187, v155, v127
    v_fma_f32 v180, -v152, v140, v180
    v_fma_f32 v184, v148, v140, v184
    v_fma_f32 v181, -v153, v141, v181
    v_fma_f32 v185, v149, v141, v185
    v_fma_f32 v182, -v154, v142, v182
    v_fma_f32 v186, v150, v142, v186
    v_fma_f32 v183, -v155, v143, v183
    v_fma_f32 v187, v151, v143, v187
    v_cvt_pk_bf16_f32 v200, v180, v181
    v_cvt_pk_bf16_f32 v201, v182, v183
    v_cvt_pk_bf16_f32 v202, v184, v185
    v_cvt_pk_bf16_f32 v203, v186, v187
    ds_write_b128 v234, v[200:203] offset:192
    v_mov_b32 v253, 1
    s_mov_b64 exec, 1
    ds_add_u32 v252, v253
    s_mov_b64 exec, -1
    s_waitcnt vmcnt(1)
    s_mov_b64 exec, 1
    ds_add_rtn_u32 v180, v255, v253 offset:4
    s_mov_b64 exec, -1
    v_cvt_f32_i32 v64, v64
    v_cvt_f32_i32 v68, v68
    v_cvt_f32_i32 v72, v72
    v_cvt_f32_i32 v76, v76
    v_cvt_f32_i32 v80, v80
    v_cvt_f32_i32 v84, v84
    v_cvt_f32_i32 v88, v88
    v_cvt_f32_i32 v92, v92
    v_fma_f32 v64, v64, v164, -v172
    v_fma_f32 v68, v68, v165, -v173
    v_fma_f32 v72, v72, v166, -v174
    v_fma_f32 v76, v76, v167, -v175
    v_fma_f32 v80, v80, v168, -v176
    v_fma_f32 v84, v84, v169, -v177
    v_fma_f32 v88, v88, v170, -v178
    v_fma_f32 v92, v92, v171, -v179
    v_cvt_pk_bf16_f32 v32, v64, v68
    v_cvt_pk_bf16_f32 v33, v72, v76
    v_cvt_pk_bf16_f32 v34, v80, v84
    v_cvt_pk_bf16_f32 v35, v88, v92
    v_cvt_f32_i32 v65, v65
    v_cvt_f32_i32 v69, v69
    v_cvt_f32_i32 v73, v73
    v_cvt_f32_i32 v77, v77
    v_cvt_f32_i32 v81, v81
    v_cvt_f32_i32 v85, v85
    v_cvt_f32_i32 v89, v89
    v_cvt_f32_i32 v93, v93
    v_fma_f32 v65, v65, v164, -v172
    v_fma_f32 v69, v69, v165, -v173
    v_fma_f32 v73, v73, v166, -v174
    v_fma_f32 v77, v77, v167, -v175
    v_fma_f32 v81, v81, v168, -v176
    v_fma_f32 v85, v85, v169, -v177
    v_fma_f32 v89, v89, v170, -v178
    v_fma_f32 v93, v93, v171, -v179
    v_cvt_pk_bf16_f32 v36, v65, v69
    v_cvt_pk_bf16_f32 v37, v73, v77
    v_cvt_pk_bf16_f32 v38, v81, v85
    v_cvt_pk_bf16_f32 v39, v89, v93
    v_cvt_f32_i32 v66, v66
    v_cvt_f32_i32 v70, v70
    v_cvt_f32_i32 v74, v74
    v_cvt_f32_i32 v78, v78
    v_cvt_f32_i32 v82, v82
    v_cvt_f32_i32 v86, v86
    v_cvt_f32_i32 v90, v90
    v_cvt_f32_i32 v94, v94
    v_fma_f32 v66, v66, v164, -v172
    v_fma_f32 v70, v70, v165, -v173
    v_fma_f32 v74, v74, v166, -v174
    v_fma_f32 v78, v78, v167, -v175
    v_fma_f32 v82, v82, v168, -v176
    v_fma_f32 v86, v86, v169, -v177
    v_fma_f32 v90, v90, v170, -v178
    v_fma_f32 v94, v94, v171, -v179
    v_cvt_pk_bf16_f32 v40, v66, v70
    v_cvt_pk_bf16_f32 v41, v74, v78
    v_cvt_pk_bf16_f32 v42, v82, v86
    v_cvt_pk_bf16_f32 v43, v90, v94
    v_cvt_f32_i32 v67, v67
    v_cvt_f32_i32 v71, v71
    v_cvt_f32_i32 v75, v75
    v_cvt_f32_i32 v79, v79
    v_cvt_f32_i32 v83, v83
    v_cvt_f32_i32 v87, v87
    v_cvt_f32_i32 v91, v91
    v_cvt_f32_i32 v95, v95
    v_fma_f32 v67, v67, v164, -v172
    v_fma_f32 v71, v71, v165, -v173
    v_fma_f32 v75, v75, v166, -v174
    v_fma_f32 v79, v79, v167, -v175
    v_fma_f32 v83, v83, v168, -v176
    v_fma_f32 v87, v87, v169, -v177
    v_fma_f32 v91, v91, v170, -v178
    v_fma_f32 v95, v95, v171, -v179
    v_cvt_pk_bf16_f32 v44, v67, v71
    v_cvt_pk_bf16_f32 v45, v75, v79
    v_cvt_pk_bf16_f32 v46, v83, v87
    v_cvt_pk_bf16_f32 v47, v91, v95
    s_waitcnt lgkmcnt(0)
    v_readfirstlane_b32 s3, v180
    s_nop 0
    s_cmp_lg_u32 s3, 0
    s_cbranch_scc1 L_hv1
    ds_write_b128 v254, v[0:3] offset:0
    ds_write_b128 v254, v[4:7] offset:1024
    ds_write_b128 v254, v[8:11] offset:2048
    ds_write_b128 v254, v[12:15] offset:3072
    ds_write_b128 v254, v[32:35] offset:4096
    ds_write_b128 v254, v[36:39] offset:5120
    ds_write_b128 v254, v[40:43] offset:6144
    ds_write_b128 v254, v[44:47] offset:7168
    ds_write_b32 v255, v253
    s_xor_b32 s100, s100, 2
    v_xor_b32 v235, 0x200, v235
    s_mov_b64 s[28:29], 0
L_hv1:
    global_load_dwordx2 v[236:237], v235, s[30:31] sc1
    global_store_dwordx4 v226, v[0:3], s[30:31] offset:-4096 sc1
    global_store_dwordx4 v226, v[4:7], s[30:31] offset:-3072 sc1
    global_store_dwordx4 v226, v[8:11], s[30:31] offset:-2048 sc1
    global_store_dwordx4 v226, v[12:15], s[30:31] offset:-1024 sc1
    v_add_u32 v226, 0x2000, v226
    global_store_dwordx4 v226, v[32:35], s[30:31] offset:-4096 sc1
    global_store_dwordx4 v226, v[36:39], s[30:31] offset:-3072 sc1
    global_store_dwordx4 v226, v[40:43], s[30:31] offset:-2048 sc1
    global_store_dwordx4 v226, v[44:47], s[30:31] offset:-1024 sc1
    s_lshl2_add_u32 s52, s46, s100
    s_lshl_b32 s52, s52, 18
    s_add_u32 s32, s30, s52
    s_addc_u32 s33, s31, 0
    s_andn2_b64 s[44:45], s[44:45], s[28:29]
    s_sub_u32 s43, 3, s3
    s_cmp_eq_u32 s3, 0
    s_cbranch_scc1 L_hv2
L_lw:
    ds_read_b32 v253, v255
    s_waitcnt lgkmcnt(0)
    v_readfirstlane_b32 s52, v253
    s_nop 0
    s_cmp_eq_u32 s52, 0
    s_cbranch_scc1 L_lw
    s_bitcmp1_b32 s42, 0
    s_cbranch_scc1 L_hv3
    ds_read_b128 a[64:67], v228 offset:0
    ds_read_b128 a[80:83], v254 offset:0
    ds_read_b128 a[144:147], v254 offset:4096
    ds_read_b128 a[68:71], v228 offset:1088
    ds_read_b128 a[84:87], v254 offset:1024
    ds_read_b128 a[148:151], v254 offset:5120
    ds_read_b128 a[72:75], v228 offset:2176
    ds_read_b128 a[88:91], v254 offset:2048
    ds_read_b128 a[152:155], v254 offset:6144
    ds_read_b128 a[76:79], v228 offset:3264
    ds_read_b128 a[92:95], v254 offset:3072
    ds_read_b128 a[156:159], v254 offset:7168
    v_accvgpr_write_b32 a128, v32
    v_accvgpr_write_b32 a129, v33
    v_accvgpr_write_b32 a130, v34
    v_accvgpr_write_b32 a131, v35
    v_accvgpr_write_b32 a132, v36
    v_accvgpr_write_b32 a133, v37
    v_accvgpr_write_b32 a134, v38
    v_accvgpr_write_b32 a135, v39
    v_accvgpr_write_b32 a136, v40
    v_accvgpr_write_b32 a137, v41
    v_accvgpr_write_b32 a138, v42
    v_accvgpr_write_b32 a139, v43
    v_accvgpr_write_b32 a140, v44
    v_accvgpr_write_b32 a141, v45
    v_accvgpr_write_b32 a142, v46
    v_accvgpr_write_b32 a143, v47
    s_branch L_hv2
L_hv3:
    ds_read_b128 a[80:83], v228 offset:0
    ds_read_b128 a[64:67], v254 offset:0
    ds_read_b128 a[128:131], v254 offset:4096
    ds_read_b128 a[84:87], v228 offset:1088
    ds_read_b128 a[68:71], v254 offset:1024
    ds_read_b128 a[132:135], v254 offset:5120
    ds_read_b128 a[88:91], v228 offset:2176
    ds_read_b128 a[72:75], v254 offset:2048
    ds_read_b128 a[136:139], v254 offset:6144
    ds_read_b128 a[92:95], v228 offset:3264
    ds_read_b128 a[76:79], v254 offset:3072
    ds_read_b128 a[140:143], v254 offset:7168
    v_accvgpr_write_b32 a144, v32
    v_accvgpr_write_b32 a145, v33
    v_accvgpr_write_b32 a146, v34
    v_accvgpr_write_b32 a147, v35
    v_accvgpr_write_b32 a148, v36
    v_accvgpr_write_b32 a149, v37
    v_accvgpr_write_b32 a150, v38
    v_accvgpr_write_b32 a151, v39
    v_accvgpr_write_b32 a152, v40
    v_accvgpr_write_b32 a153, v41
    v_accvgpr_write_b32 a154, v42
    v_accvgpr_write_b32 a155, v43
    v_accvgpr_write_b32 a156, v44
    v_accvgpr_write_b32 a157, v45
    v_accvgpr_write_b32 a158, v46
    v_accvgpr_write_b32 a159, v47
L_hv2:
L_lsb:
    ds_read_b32 v253, v252
    s_waitcnt lgkmcnt(0)
    v_readfirstlane_b32 s52, v253
    s_nop 0
    s_cmp_lt_u32 s52, 4
    s_cbranch_scc1 L_lsb
    s_xor_b32 s52, s42, 3
    s_mul_i32 s52, s52, 4352
    s_add_u32 s52, s52, 98304
    v_add_u32 v241, s52, v239
    ds_read_b128 a[0:3], v241 offset:0
    ds_read_b128 a[4:7], v241 offset:1088
    ds_read_b128 a[8:11], v241 offset:2176
    ds_read_b128 a[12:15], v241 offset:3264
    s_xor_b32 s52, s42, 2
    s_mul_i32 s52, s52, 4352
    s_add_u32 s52, s52, 98304
    v_add_u32 v241, s52, v239
    ds_read_b128 a[16:19], v241 offset:0
    ds_read_b128 a[20:23], v241 offset:1088
    ds_read_b128 a[24:27], v241 offset:2176
    ds_read_b128 a[28:31], v241 offset:3264
    s_xor_b32 s52, s42, 1
    s_mul_i32 s52, s52, 4352
    s_add_u32 s52, s52, 98304
    v_add_u32 v241, s52, v239
    ds_read_b128 a[32:35], v241 offset:0
    ds_read_b128 a[36:39], v241 offset:1088
    ds_read_b128 a[40:43], v241 offset:2176
    ds_read_b128 a[44:47], v241 offset:3264
    s_xor_b32 s52, s42, 0
    s_mul_i32 s52, s52, 4352
    s_add_u32 s52, s52, 98304
    v_add_u32 v241, s52, v239
    ds_read_b128 a[48:51], v241 offset:0
    ds_read_b128 a[52:55], v241 offset:1088
    ds_read_b128 a[56:59], v241 offset:2176
    ds_read_b128 a[60:63], v241 offset:3264
    v_mov_b32 v192, 0
    v_mov_b32 v193, 0
    v_mov_b32 v194, 0
    v_mov_b32 v195, 0
    v_mov_b32 v196, 0
    v_mov_b32 v197, 0
    v_mov_b32 v198, 0
    v_mov_b32 v199, 0
    v_mov_b32 v200, 0
    v_mov_b32 v201, 0
    v_mov_b32 v202, 0
    v_mov_b32 v203, 0
    v_mov_b32 v204, 0
    v_mov_b32 v205, 0
    v_mov_b32 v206, 0
    v_mov_b32 v207, 0
    s_waitcnt vmcnt(8)
    v_cmp_gt_u64 vcc, s[56:57], v[236:237]
    v_cmp_lt_u64 s[60:61], s[58:59], v[236:237]
    s_nop 0
    s_nor_b64 s[18:19], vcc, s[60:61]
    s_lshr_b64 s[20:21], s[18:19], 1
    s_and_b64 s[18:19], s[18:19], s[44:45]
    s_and_b64 s[18:19], s[18:19], s[20:21]
    s_or_b64 s[22:23], s[22:23], s[18:19]
    s_bcnt1_i32_b64 s20, s[22:23]
    s_xor_b64 s[44:45], s[44:45], s[18:19]
    s_cmp_ge_u32 s20, s43
    s_cselect_b32 s24, 1, 0
    s_cbranch_scc0 L_sp0
    s_cmp_lg_u32 s3, 0
    s_cbranch_scc1 L_fl1
    s_ff1_i32_b64 s38, s[22:23]
    s_bitset0_b64 s[22:23], s38
    s_lshl_b32 s38, s38, 13
    s_and_b32 s37, s38, 0x3ffff
    buffer_load_dwordx4 a[64:67], v212, s[32:35], s37 offen offset:0 sc1
    buffer_load_dwordx4 a[68:71], v212, s[32:35], s37 offen offset:1024 sc1
    buffer_load_dwordx4 a[72:75], v212, s[32:35], s37 offen offset:2048 sc1
    buffer_load_dwordx4 a[76:79], v212, s[32:35], s37 offen offset:3072 sc1
    buffer_load_dwordx4 a[80:83], v213, s[32:35], s37 offen offset:0 sc1
    buffer_load_dwordx4 a[84:87], v213, s[32:35], s37 offen offset:1024 sc1
    buffer_load_dwordx4 a[88:91], v213, s[32:35], s37 offen offset:2048 sc1
    buffer_load_dwordx4 a[92:95], v213, s[32:35], s37 offen offset:3072 sc1
    buffer_load_dwordx4 a[128:131], v214, s[32:35], s37 offen offset:0 sc1
    buffer_load_dwordx4 a[132:135], v214, s[32:35], s37 offen offset:1024 sc1
    buffer_load_dwordx4 a[136:139], v214, s[32:35], s37 offen offset:2048 sc1
    buffer_load_dwordx4 a[140:143], v214, s[32:35], s37 offen offset:3072 sc1
    buffer_load_dwordx4 a[144:147], v215, s[32:35], s37 offen offset:0 sc1
    buffer_load_dwordx4 a[148:151], v215, s[32:35], s37 offen offset:1024 sc1
    buffer_load_dwordx4 a[152:155], v215, s[32:35], s37 offen offset:2048 sc1
    buffer_load_dwordx4 a[156:159], v215, s[32:35], s37 offen offset:3072 sc1
    s_cmp_lg_u32 s3, 0
L_fl1:
    s_waitcnt vmcnt(16)
    s_cbranch_scc0 L_p1
    s_waitcnt vmcnt(0)
L_p1:
    s_mov_b64 exec, 1
    global_store_dwordx2 v240, v[250:251], s[30:31]
    s_mov_b64 exec, -1
    s_branch L_nopoll
L_sp0:
    global_load_dwordx2 v[236:237], v235, s[30:31] sc1
    s_waitcnt vmcnt(1)
    s_mov_b64 exec, 1
    global_store_dwordx2 v240, v[250:251], s[30:31]
    s_mov_b64 exec, -1
    global_load_dwordx2 v[236:237], v235, s[30:31] sc1
    s_waitcnt vmcnt(2)
    v_cmp_gt_u64 vcc, s[56:57], v[236:237]
    v_cmp_lt_u64 s[60:61], s[58:59], v[236:237]
    s_nop 0
    s_nor_b64 s[18:19], vcc, s[60:61]
    s_lshr_b64 s[20:21], s[18:19], 1
    s_and_b64 s[18:19], s[18:19], s[44:45]
    s_and_b64 s[18:19], s[18:19], s[20:21]
    s_or_b64 s[22:23], s[22:23], s[18:19]
    s_bcnt1_i32_b64 s20, s[22:23]
    s_xor_b64 s[44:45], s[44:45], s[18:19]
    s_cmp_ge_u32 s20, s43
    s_cselect_b32 s24, 1, 0
    s_cbranch_scc0 L_nopoll
    s_cmp_lg_u32 s3, 0
    s_cbranch_scc1 L_fl2
    s_ff1_i32_b64 s38, s[22:23]
    s_bitset0_b64 s[22:23], s38
    s_lshl_b32 s38, s38, 13
    s_and_b32 s37, s38, 0x3ffff
    buffer_load_dwordx4 a[64:67], v212, s[32:35], s37 offen offset:0 sc1
    buffer_load_dwordx4 a[68:71], v212, s[32:35], s37 offen offset:1024 sc1
    buffer_load_dwordx4 a[72:75], v212, s[32:35], s37 offen offset:2048 sc1
    buffer_load_dwordx4 a[76:79], v212, s[32:35], s37 offen offset:3072 sc1
    buffer_load_dwordx4 a[80:83], v213, s[32:35], s37 offen offset:0 sc1
    buffer_load_dwordx4 a[84:87], v213, s[32:35], s37 offen offset:1024 sc1
    buffer_load_dwordx4 a[88:91], v213, s[32:35], s37 offen offset:2048 sc1
    buffer_load_dwordx4 a[92:95], v213, s[32:35], s37 offen offset:3072 sc1
    buffer_load_dwordx4 a[128:131], v214, s[32:35], s37 offen offset:0 sc1
    buffer_load_dwordx4 a[132:135], v214, s[32:35], s37 offen offset:1024 sc1
    buffer_load_dwordx4 a[136:139], v214, s[32:35], s37 offen offset:2048 sc1
    buffer_load_dwordx4 a[140:143], v214, s[32:35], s37 offen offset:3072 sc1
    buffer_load_dwordx4 a[144:147], v215, s[32:35], s37 offen offset:0 sc1
    buffer_load_dwordx4 a[148:151], v215, s[32:35], s37 offen offset:1024 sc1
    buffer_load_dwordx4 a[152:155], v215, s[32:35], s37 offen offset:2048 sc1
    buffer_load_dwordx4 a[156:159], v215, s[32:35], s37 offen offset:3072 sc1
    s_cmp_lg_u32 s3, 0
L_fl2:
L_nopoll:
    s_cmp_lg_u32 s24, 0
    s_cbranch_scc1 L_peel
    s_mov_b32 s40, 400
L_poll:
    s_waitcnt vmcnt(0)
    v_cmp_gt_u64 vcc, s[56:57], v[236:237]
    v_cmp_lt_u64 s[60:61], s[58:59], v[236:237]
    s_nop 0
    s_nor_b64 s[18:19], vcc, s[60:61]
    s_lshr_b64 s[20:21], s[18:19], 1
    s_and_b64 s[18:19], s[18:19], s[44:45]
    s_and_b64 s[18:19], s[18:19], s[20:21]
    s_or_b64 s[22:23], s[22:23], s[18:19]
    s_bcnt1_i32_b64 s20, s[22:23]
    s_xor_b64 s[44:45], s[44:45], s[18:19]
    s_cmp_ge_u32 s20, s43
    s_cbranch_scc1 L_ready
    global_load_dwordx2 v[236:237], v235, s[30:31] sc1
    s_sub_u32 s40, s40, 1
    s_cmp_lg_u32 s40, 0
    s_cbranch_scc1 L_poll
    s_branch L_selfprep
L_ready:
    s_cmp_lg_u32 s3, 0
    s_cbranch_scc1 L_fl3
    s_ff1_i32_b64 s38, s[22:23]
    s_bitset0_b64 s[22:23], s38
    s_lshl_b32 s38, s38, 13
    s_and_b32 s37, s38, 0x3ffff
    buffer_load_dwordx4 a[64:67], v212, s[32:35], s37 offen offset:0 sc1
    buffer_load_dwordx4 a[68:71], v212, s[32:35], s37 offen offset:1024 sc1
    buffer_load_dwordx4 a[72:75], v212, s[32:35], s37 offen offset:2048 sc1
    buffer_load_dwordx4 a[76:79], v212, s[32:35], s37 offen offset:3072 sc1
    buffer_load_dwordx4 a[80:83], v213, s[32:35], s37 offen offset:0 sc1
    buffer_load_dwordx4 a[84:87], v213, s[32:35], s37 offen offset:1024 sc1
    buffer_load_dwordx4 a[88:91], v213, s[32:35], s37 offen offset:2048 sc1
    buffer_load_dwordx4 a[92:95], v213, s[32:35], s37 offen offset:3072 sc1
    buffer_load_dwordx4 a[128:131], v214, s[32:35], s37 offen offset:0 sc1
    buffer_load_dwordx4 a[132:135], v214, s[32:35], s37 offen offset:1024 sc1
    buffer_load_dwordx4 a[136:139], v214, s[32:35], s37 offen offset:2048 sc1
    buffer_load_dwordx4 a[140:143], v214, s[32:35], s37 offen offset:3072 sc1
    buffer_load_dwordx4 a[144:147], v215, s[32:35], s37 offen offset:0 sc1
    buffer_load_dwordx4 a[148:151], v215, s[32:35], s37 offen offset:1024 sc1
    buffer_load_dwordx4 a[152:155], v215, s[32:35], s37 offen offset:2048 sc1
    buffer_load_dwordx4 a[156:159], v215, s[32:35], s37 offen offset:3072 sc1
    s_cmp_lg_u32 s3, 0
L_fl3:
L_peel:
    s_ff1_i32_b64 s38, s[22:23]
    s_bitset0_b64 s[22:23], s38
    s_lshl_b32 s38, s38, 13
    s_and_b32 s101, s38, 0x3ffff
    s_ff1_i32_b64 s38, s[22:23]
    s_bitset0_b64 s[22:23], s38
    s_lshl_b32 s38, s38, 13
    s_and_b32 s36, s38, 0x3ffff
    v_mfma_f32_32x32x16_bf16 v[64:79], v[246:249], v[246:249], 0
    v_mfma_f32_32x32x16_bf16 v[80:95], v[246:249], v[246:249], 0
    v_mfma_f32_32x32x16_bf16 v[96:111], v[246:249], v[246:249], 0
    v_mfma_f32_32x32x16_bf16 v[112:127], v[246:249], v[246:249], 0
    v_mfma_f32_32x32x16_bf16 v[128:143], v[246:249], v[246:249], 0
    s_waitcnt lgkmcnt(0)
    s_waitcnt vmcnt(14)
    v_mfma_f32_16x16x32_bf16 v[144:147], a[64:67], a[0:3], v[192:195]
    buffer_load_dwordx4 a[96:99], v212, s[32:35], s101 offen offset:0 sc1
    v_mfma_f32_16x16x32_bf16 v[144:147], a[68:71], a[4:7], v[144:147]
    s_waitcnt vmcnt(13)
    v_mfma_f32_16x16x32_bf16 v[144:147], a[72:75], a[8:11], v[144:147]
    buffer_load_dwordx4 a[100:103], v212, s[32:35], s101 offen offset:1024 sc1
    v_mfma_f32_16x16x32_bf16 v[144:147], a[76:79], a[12:15], v[144:147]
    v_mfma_f32_16x16x32_bf16 v[152:155], a[64:67], a[16:19], v[196:199]
    v_mfma_f32_16x16x32_bf16 v[152:155], a[68:71], a[20:23], v[152:155]
    buffer_load_dwordx4 a[104:107], v212, s[32:35], s101 offen offset:2048 sc1
    v_mfma_f32_16x16x32_bf16 v[152:155], a[72:75], a[24:27], v[152:155]
    v_mfma_f32_16x16x32_bf16 v[152:155], a[76:79], a[28:31], v[152:155]
    s_waitcnt vmcnt(13)
    v_mfma_f32_16x16x32_bf16 v[148:151], a[80:83], a[0:3], v[192:195]
    buffer_load_dwordx4 a[108:111], v212, s[32:35], s101 offen offset:3072 sc1
    v_mfma_f32_16x16x32_bf16 v[148:151], a[84:87], a[4:7], v[148:151]
    s_waitcnt vmcnt(12)
    v_mfma_f32_16x16x32_bf16 v[148:151], a[88:91], a[8:11], v[148:151]
    v_mfma_f32_16x16x32_bf16 v[148:151], a[92:95], a[12:15], v[148:151]
    buffer_load_dwordx4 a[112:115], v213, s[32:35], s101 offen offset:0 sc1
    v_mfma_f32_16x16x32_bf16 v[156:159], a[80:83], a[16:19], v[196:199]
    v_exp_f32 v144, v144
    v_mfma_f32_16x16x32_bf16 v[156:159], a[84:87], a[20:23], v[156:159]
    v_exp_f32 v145, v145
    v_mfma_f32_16x16x32_bf16 v[156:159], a[88:91], a[24:27], v[156:159]
    v_exp_f32 v146, v146
    v_cvt_pk_bf16_f32 v176, v144, v145
    buffer_load_dwordx4 a[116:119], v213, s[32:35], s101 offen offset:1024 sc1
    v_mfma_f32_16x16x32_bf16 v[156:159], a[92:95], a[28:31], v[156:159]
    v_exp_f32 v147, v147
    v_mfma_f32_16x16x32_bf16 v[160:163], a[64:67], a[32:35], v[200:203]
    v_exp_f32 v152, v152
    v_cvt_pk_bf16_f32 v177, v146, v147
    v_mfma_f32_16x16x32_bf16 v[160:163], a[68:71], a[36:39], v[160:163]
    v_exp_f32 v153, v153
    buffer_load_dwordx4 a[120:123], v213, s[32:35], s101 offen offset:2048 sc1
    v_mfma_f32_16x16x32_bf16 v[160:163], a[72:75], a[40:43], v[160:163]
    v_exp_f32 v154, v154
    v_cvt_pk_bf16_f32 v180, v152, v153
    v_mfma_f32_16x16x32_bf16 v[160:163], a[76:79], a[44:47], v[160:163]
    v_exp_f32 v155, v155
    v_mfma_f32_16x16x32_bf16 v[168:171], a[64:67], a[48:51], v[204:207]
    v_exp_f32 v148, v148
    v_cvt_pk_bf16_f32 v181, v154, v155
    buffer_load_dwordx4 a[124:127], v213, s[32:35], s101 offen offset:3072 sc1
    v_mfma_f32_16x16x32_bf16 v[168:171], a[68:71], a[52:55], v[168:171]
    v_exp_f32 v149, v149
    v_mfma_f32_16x16x32_bf16 v[168:171], a[72:75], a[56:59], v[168:171]
    v_exp_f32 v150, v150
    v_cvt_pk_bf16_f32 v178, v148, v149
    v_mfma_f32_16x16x32_bf16 v[168:171], a[76:79], a[60:63], v[168:171]
    v_exp_f32 v151, v151
    buffer_load_dwordx4 a[160:163], v214, s[32:35], s101 offen offset:0 sc1
    v_mfma_f32_16x16x32_bf16 v[164:167], a[80:83], a[32:35], v[200:203]
    v_exp_f32 v156, v156
    v_cvt_pk_bf16_f32 v179, v150, v151
    v_mfma_f32_16x16x32_bf16 v[164:167], a[84:87], a[36:39], v[164:167]
    v_exp_f32 v157, v157
    v_mfma_f32_16x16x32_bf16 v[164:167], a[88:91], a[40:43], v[164:167]
    v_exp_f32 v158, v158
    v_cvt_pk_bf16_f32 v182, v156, v157
    buffer_load_dwordx4 a[164:167], v214, s[32:35], s101 offen offset:1024 sc1
    v_mfma_f32_16x16x32_bf16 v[164:167], a[92:95], a[44:47], v[164:167]
    v_exp_f32 v159, v159
    v_mfma_f32_16x16x32_bf16 v[172:175], a[80:83], a[48:51], v[204:207]
    v_cvt_pk_bf16_f32 v183, v158, v159
    v_mfma_f32_16x16x32_bf16 v[172:175], a[84:87], a[52:55], v[172:175]
    buffer_load_dwordx4 a[168:171], v214, s[32:35], s101 offen offset:2048 sc1
    v_mfma_f32_16x16x32_bf16 v[172:175], a[88:91], a[56:59], v[172:175]
    v_exp_f32 v160, v160
    v_mfma_f32_16x16x32_bf16 v[172:175], a[92:95], a[60:63], v[172:175]
    s_waitcnt vmcnt(17)
    v_mfma_f32_16x16x32_bf16 v[0:3], v[176:179], a[128:131], 0
    v_exp_f32 v161, v161
    buffer_load_dwordx4 a[172:175], v214, s[32:35], s101 offen offset:3072 sc1
    v_mfma_f32_16x16x32_bf16 v[32:35], v[180:183], a[128:131], 0
    v_cvt_pk_bf16_f32 v184, v160, v161
    v_mfma_f32_16x16x32_bf16 v[4:7], v[176:179], a[132:135], 0
    v_exp_f32 v162, v162
    v_mfma_f32_16x16x32_bf16 v[36:39], v[180:183], a[132:135], 0
    buffer_load_dwordx4 a[176:179], v215, s[32:35], s101 offen offset:0 sc1
    s_waitcnt vmcnt(17)
    v_mfma_f32_16x16x32_bf16 v[8:11], v[176:179], a[136:139], 0
    v_exp_f32 v163, v163
    v_mfma_f32_16x16x32_bf16 v[40:43], v[180:183], a[136:139], 0
    v_cvt_pk_bf16_f32 v185, v162, v163
    v_mfma_f32_16x16x32_bf16 v[12:15], v[176:179], a[140:143], 0
    v_exp_f32 v168, v168
    buffer_load_dwordx4 a[180:183], v215, s[32:35], s101 offen offset:1024 sc1
    v_mfma_f32_16x16x32_bf16 v[44:47], v[180:183], a[140:143], 0
    s_waitcnt vmcnt(16)
    v_mfma_f32_16x16x32_bf16 v[16:19], v[176:179], a[144:147], 0
    v_exp_f32 v169, v169
    v_mfma_f32_16x16x32_bf16 v[48:51], v[180:183], a[144:147], 0
    v_cvt_pk_bf16_f32 v188, v168, v169
    buffer_load_dwordx4 a[184:187], v215, s[32:35], s101 offen offset:2048 sc1
    v_mfma_f32_16x16x32_bf16 v[20:23], v[176:179], a[148:151], 0
    v_exp_f32 v170, v170
    v_mfma_f32_16x16x32_bf16 v[52:55], v[180:183], a[148:151], 0
    s_waitcnt vmcnt(15)
    v_mfma_f32_16x16x32_bf16 v[24:27], v[176:179], a[152:155], 0
    v_exp_f32 v171, v171
    global_load_dwordx2 v[236:237], v235, s[30:31] sc1
    buffer_load_dwordx4 a[188:191], v215, s[32:35], s101 offen offset:3072 sc1
    v_mfma_f32_16x16x32_bf16 v[56:59], v[180:183], a[152:155], 0
    v_cvt_pk_bf16_f32 v189, v170, v171
    v_mfma_f32_16x16x32_bf16 v[28:31], v[176:179], a[156:159], 0
    v_exp_f32 v164, v164
    v_mfma_f32_16x16x32_bf16 v[60:63], v[180:183], a[156:159], 0
    buffer_load_dwordx4 a[64:67], v212, s[32:35], s36 offen offset:0 sc1
    v_mfma_f32_16x16x32_bf16 v[128:131], v[176:179], v[208:211], 0
    v_mfma_f32_16x16x32_bf16 v[132:135], v[180:183], v[208:211], 0
    s_waitcnt vmcnt(14)
    s_branch L_mid
.p2align 6
L_loop:
    v_mfma_f32_16x16x32_bf16 v[144:147], a[64:67], a[0:3], v[192:195]
    v_exp_f32 v165, v165
    v_mfma_f32_16x16x32_bf16 v[144:147], a[68:71], a[4:7], v[144:147]
    v_cvt_pk_bf16_f32 v186, v164, v165
    v_mfma_f32_16x16x32_bf16 v[144:147], a[72:75], a[8:11], v[144:147]
    v_exp_f32 v166, v166
    v_mfma_f32_16x16x32_bf16 v[144:147], a[76:79], a[12:15], v[144:147]
    buffer_load_dwordx4 a[100:103], v212, s[32:35], s36 offen offset:1024 sc1
    v_mfma_f32_16x16x32_bf16 v[152:155], a[64:67], a[16:19], v[196:199]
    v_exp_f32 v167, v167
    v_mfma_f32_16x16x32_bf16 v[152:155], a[68:71], a[20:23], v[152:155]
    v_cvt_pk_bf16_f32 v187, v166, v167
    s_waitcnt vmcnt(10)
    v_mfma_f32_16x16x32_bf16 v[152:155], a[72:75], a[24:27], v[152:155]
    v_exp_f32 v172, v172
    v_mfma_f32_16x16x32_bf16 v[152:155], a[76:79], a[28:31], v[152:155]
    buffer_load_dwordx4 a[104:107], v212, s[32:35], s36 offen offset:2048 sc1
    v_mfma_f32_16x16x32_bf16 v[148:151], a[80:83], a[0:3], v[192:195]
    v_exp_f32 v173, v173
    v_mfma_f32_16x16x32_bf16 v[148:151], a[84:87], a[4:7], v[148:151]
    v_cvt_pk_bf16_f32 v190, v172, v173
    v_mfma_f32_16x16x32_bf16 v[148:151], a[88:91], a[8:11], v[148:151]
    v_exp_f32 v174, v174
    v_mfma_f32_16x16x32_bf16 v[148:151], a[92:95], a[12:15], v[148:151]
    buffer_load_dwordx4 a[108:111], v212, s[32:35], s36 offen offset:3072 sc1
    v_mfma_f32_16x16x32_bf16 v[156:159], a[80:83], a[16:19], v[196:199]
    v_exp_f32 v175, v175
    v_mfma_f32_16x16x32_bf16 v[156:159], a[84:87], a[20:23], v[156:159]
    v_cvt_pk_bf16_f32 v191, v174, v175
    v_mfma_f32_16x16x32_bf16 v[156:159], a[88:91], a[24:27], v[156:159]
    v_exp_f32 v144, v144
    v_mfma_f32_16x16x32_bf16 v[156:159], a[92:95], a[28:31], v[156:159]
    buffer_load_dwordx4 a[112:115], v213, s[32:35], s36 offen offset:0 sc1
    v_mfma_f32_16x16x32_bf16 v[64:67], v[184:187], a[160:163], v[64:67]
    v_exp_f32 v145, v145
    v_mfma_f32_16x16x32_bf16 v[96:99], v[188:191], a[160:163], v[96:99]
    v_cvt_pk_bf16_f32 v176, v144, v145
    v_mfma_f32_16x16x32_bf16 v[68:71], v[184:187], a[164:167], v[68:71]
    v_exp_f32 v146, v146
    v_mfma_f32_16x16x32_bf16 v[100:103], v[188:191], a[164:167], v[100:103]
    buffer_load_dwordx4 a[116:119], v213, s[32:35], s36 offen offset:1024 sc1
    v_mfma_f32_16x16x32_bf16 v[72:75], v[184:187], a[168:171], v[72:75]
    v_exp_f32 v147, v147
    v_mfma_f32_16x16x32_bf16 v[104:107], v[188:191], a[168:171], v[104:107]
    v_cvt_pk_bf16_f32 v177, v146, v147
    v_mfma_f32_16x16x32_bf16 v[76:79], v[184:187], a[172:175], v[76:79]
    v_exp_f32 v152, v152
    v_mfma_f32_16x16x32_bf16 v[108:111], v[188:191], a[172:175], v[108:111]
    buffer_load_dwordx4 a[120:123], v213, s[32:35], s36 offen offset:2048 sc1
    v_mfma_f32_16x16x32_bf16 v[80:83], v[184:187], a[176:179], v[80:83]
    v_exp_f32 v153, v153
    v_mfma_f32_16x16x32_bf16 v[112:115], v[188:191], a[176:179], v[112:115]
    v_cvt_pk_bf16_f32 v180, v152, v153
    v_mfma_f32_16x16x32_bf16 v[84:87], v[184:187], a[180:183], v[84:87]
    v_exp_f32 v154, v154
    v_mfma_f32_16x16x32_bf16 v[116:119], v[188:191], a[180:183], v[116:119]
    buffer_load_dwordx4 a[124:127], v213, s[32:35], s36 offen offset:3072 sc1
    v_mfma_f32_16x16x32_bf16 v[88:91], v[184:187], a[184:187], v[88:91]
    v_exp_f32 v155, v155
    v_mfma_f32_16x16x32_bf16 v[120:123], v[188:191], a[184:187], v[120:123]
    v_cvt_pk_bf16_f32 v181, v154, v155
    v_mfma_f32_16x16x32_bf16 v[92:95], v[184:187], a[188:191], v[92:95]
    v_exp_f32 v148, v148
    v_mfma_f32_16x16x32_bf16 v[124:127], v[188:191], a[188:191], v[124:127]
    buffer_load_dwordx4 a[160:163], v214, s[32:35], s36 offen offset:0 sc1
    v_mfma_f32_16x16x32_bf16 v[136:139], v[184:187], v[208:211], v[136:139]
    v_mfma_f32_16x16x32_bf16 v[140:143], v[188:191], v[208:211], v[140:143]
    v_mfma_f32_16x16x32_bf16 v[160:163], a[64:67], a[32:35], v[200:203]
    v_exp_f32 v149, v149
    v_mfma_f32_16x16x32_bf16 v[160:163], a[68:71], a[36:39], v[160:163]
    v_cvt_pk_bf16_f32 v178, v148, v149
    s_ff1_i32_b64 s38, s[22:23]
    v_mfma_f32_16x16x32_bf16 v[160:163], a[72:75], a[40:43], v[160:163]
    v_exp_f32 v150, v150
    v_mfma_f32_16x16x32_bf16 v[160:163], a[76:79], a[44:47], v[160:163]
    buffer_load_dwordx4 a[164:167], v214, s[32:35], s36 offen offset:1024 sc1
    v_mfma_f32_16x16x32_bf16 v[168:171], a[64:67], a[48:51], v[204:207]
    v_exp_f32 v151, v151
    v_mfma_f32_16x16x32_bf16 v[168:171], a[68:71], a[52:55], v[168:171]
    v_cvt_pk_bf16_f32 v179, v150, v151
    s_bitset0_b64 s[22:23], s38
    v_mfma_f32_16x16x32_bf16 v[168:171], a[72:75], a[56:59], v[168:171]
    v_exp_f32 v156, v156
    v_mfma_f32_16x16x32_bf16 v[168:171], a[76:79], a[60:63], v[168:171]
    buffer_load_dwordx4 a[168:171], v214, s[32:35], s36 offen offset:2048 sc1
    v_mfma_f32_16x16x32_bf16 v[164:167], a[80:83], a[32:35], v[200:203]
    v_exp_f32 v157, v157
    v_mfma_f32_16x16x32_bf16 v[164:167], a[84:87], a[36:39], v[164:167]
    v_cvt_pk_bf16_f32 v182, v156, v157
    s_lshl_b32 s38, s38, 13
    v_mfma_f32_16x16x32_bf16 v[164:167], a[88:91], a[40:43], v[164:167]
    v_exp_f32 v158, v158
    v_mfma_f32_16x16x32_bf16 v[164:167], a[92:95], a[44:47], v[164:167]
    buffer_load_dwordx4 a[172:175], v214, s[32:35], s36 offen offset:3072 sc1
    v_mfma_f32_16x16x32_bf16 v[172:175], a[80:83], a[48:51], v[204:207]
    v_exp_f32 v159, v159
    v_mfma_f32_16x16x32_bf16 v[172:175], a[84:87], a[52:55], v[172:175]
    v_cvt_pk_bf16_f32 v183, v158, v159
    s_waitcnt vmcnt(16)
    v_mfma_f32_16x16x32_bf16 v[172:175], a[88:91], a[56:59], v[172:175]
    v_exp_f32 v160, v160
    v_mfma_f32_16x16x32_bf16 v[172:175], a[92:95], a[60:63], v[172:175]
    buffer_load_dwordx4 a[176:179], v215, s[32:35], s36 offen offset:0 sc1
    v_mfma_f32_16x16x32_bf16 v[0:3], v[176:179], a[128:131], v[0:3]
    v_exp_f32 v161, v161
    v_mfma_f32_16x16x32_bf16 v[32:35], v[180:183], a[128:131], v[32:35]
    v_cvt_pk_bf16_f32 v184, v160, v161
    v_mfma_f32_16x16x32_bf16 v[4:7], v[176:179], a[132:135], v[4:7]
    v_exp_f32 v162, v162
    v_mfma_f32_16x16x32_bf16 v[36:39], v[180:183], a[132:135], v[36:39]
    buffer_load_dwordx4 a[180:183], v215, s[32:35], s36 offen offset:1024 sc1
    v_mfma_f32_16x16x32_bf16 v[8:11], v[176:179], a[136:139], v[8:11]
    v_exp_f32 v163, v163
    v_mfma_f32_16x16x32_bf16 v[40:43], v[180:183], a[136:139], v[40:43]
    v_cvt_pk_bf16_f32 v185, v162, v163
    s_waitcnt vmcnt(14)
    v_mfma_f32_16x16x32_bf16 v[12:15], v[176:179], a[140:143], v[12:15]
    v_exp_f32 v168, v168
    v_mfma_f32_16x16x32_bf16 v[44:47], v[180:183], a[140:143], v[44:47]
    buffer_load_dwordx4 a[184:187], v215, s[32:35], s36 offen offset:2048 sc1
    v_mfma_f32_16x16x32_bf16 v[16:19], v[176:179], a[144:147], v[16:19]
    v_exp_f32 v169, v169
    v_mfma_f32_16x16x32_bf16 v[48:51], v[180:183], a[144:147], v[48:51]
    v_cvt_pk_bf16_f32 v188, v168, v169
    v_mfma_f32_16x16x32_bf16 v[20:23], v[176:179], a[148:151], v[20:23]
    v_exp_f32 v170, v170
    v_mfma_f32_16x16x32_bf16 v[52:55], v[180:183], a[148:151], v[52:55]
    buffer_load_dwordx4 a[188:191], v215, s[32:35], s36 offen offset:3072 sc1
    v_mfma_f32_16x16x32_bf16 v[24:27], v[176:179], a[152:155], v[24:27]
    v_exp_f32 v171, v171
    v_mfma_f32_16x16x32_bf16 v[56:59], v[180:183], a[152:155], v[56:59]
    v_cvt_pk_bf16_f32 v189, v170, v171
    s_and_b32 s36, s38, 0x3ffff
    v_mfma_f32_16x16x32_bf16 v[28:31], v[176:179], a[156:159], v[28:31]
    v_exp_f32 v164, v164
    v_mfma_f32_16x16x32_bf16 v[60:63], v[180:183], a[156:159], v[60:63]
    buffer_load_dwordx4 a[64:67], v212, s[32:35], s36 offen offset:0 sc1
    v_mfma_f32_16x16x32_bf16 v[128:131], v[176:179], v[208:211], v[128:131]
    v_mfma_f32_16x16x32_bf16 v[132:135], v[180:183], v[208:211], v[132:135]
    s_waitcnt vmcnt(13)
L_mid:
    v_mfma_f32_16x16x32_bf16 v[144:147], a[96:99], a[0:3], v[192:195]
    v_exp_f32 v165, v165
    v_mfma_f32_16x16x32_bf16 v[144:147], a[100:103], a[4:7], v[144:147]
    v_cvt_pk_bf16_f32 v186, v164, v165
    v_mfma_f32_16x16x32_bf16 v[144:147], a[104:107], a[8:11], v[144:147]
    v_exp_f32 v166, v166
    v_mfma_f32_16x16x32_bf16 v[144:147], a[108:111], a[12:15], v[144:147]
    buffer_load_dwordx4 a[68:71], v212, s[32:35], s36 offen offset:1024 sc1
    v_mfma_f32_16x16x32_bf16 v[152:155], a[96:99], a[16:19], v[196:199]
    v_exp_f32 v167, v167
    v_mfma_f32_16x16x32_bf16 v[152:155], a[100:103], a[20:23], v[152:155]
    v_cvt_pk_bf16_f32 v187, v166, v167
    s_waitcnt vmcnt(10)
    v_mfma_f32_16x16x32_bf16 v[152:155], a[104:107], a[24:27], v[152:155]
    v_exp_f32 v172, v172
    v_mfma_f32_16x16x32_bf16 v[152:155], a[108:111], a[28:31], v[152:155]
    buffer_load_dwordx4 a[72:75], v212, s[32:35], s36 offen offset:2048 sc1
    v_mfma_f32_16x16x32_bf16 v[148:151], a[112:115], a[0:3], v[192:195]
    v_exp_f32 v173, v173
    v_mfma_f32_16x16x32_bf16 v[148:151], a[116:119], a[4:7], v[148:151]
    v_cvt_pk_bf16_f32 v190, v172, v173
    v_mfma_f32_16x16x32_bf16 v[148:151], a[120:123], a[8:11], v[148:151]
    v_exp_f32 v174, v174
    v_mfma_f32_16x16x32_bf16 v[148:151], a[124:127], a[12:15], v[148:151]
    buffer_load_dwordx4 a[76:79], v212, s[32:35], s36 offen offset:3072 sc1
    v_mfma_f32_16x16x32_bf16 v[156:159], a[112:115], a[16:19], v[196:199]
    v_exp_f32 v175, v175
    v_mfma_f32_16x16x32_bf16 v[156:159], a[116:119], a[20:23], v[156:159]
    v_cvt_pk_bf16_f32 v191, v174, v175
    v_mfma_f32_16x16x32_bf16 v[156:159], a[120:123], a[24:27], v[156:159]
    v_exp_f32 v144, v144
    v_mfma_f32_16x16x32_bf16 v[156:159], a[124:127], a[28:31], v[156:159]
    buffer_load_dwordx4 a[80:83], v213, s[32:35], s36 offen offset:0 sc1
    v_mfma_f32_16x16x32_bf16 v[64:67], v[184:187], a[128:131], v[64:67]
    v_exp_f32 v145, v145
    v_mfma_f32_16x16x32_bf16 v[96:99], v[188:191], a[128:131], v[96:99]
    v_cvt_pk_bf16_f32 v176, v144, v145
    v_mfma_f32_16x16x32_bf16 v[68:71], v[184:187], a[132:135], v[68:71]
    v_exp_f32 v146, v146
    v_mfma_f32_16x16x32_bf16 v[100:103], v[188:191], a[132:135], v[100:103]
    buffer_load_dwordx4 a[84:87], v213, s[32:35], s36 offen offset:1024 sc1
    v_mfma_f32_16x16x32_bf16 v[72:75], v[184:187], a[136:139], v[72:75]
    v_exp_f32 v147, v147
    v_mfma_f32_16x16x32_bf16 v[104:107], v[188:191], a[136:139], v[104:107]
    v_cvt_pk_bf16_f32 v177, v146, v147
    v_mfma_f32_16x16x32_bf16 v[76:79], v[184:187], a[140:143], v[76:79]
    v_exp_f32 v152, v152
    v_mfma_f32_16x16x32_bf16 v[108:111], v[188:191], a[140:143], v[108:111]
    buffer_load_dwordx4 a[88:91], v213, s[32:35], s36 offen offset:2048 sc1
    v_mfma_f32_16x16x32_bf16 v[80:83], v[184:187], a[144:147], v[80:83]
    v_exp_f32 v153, v153
    v_mfma_f32_16x16x32_bf16 v[112:115], v[188:191], a[144:147], v[112:115]
    v_cvt_pk_bf16_f32 v180, v152, v153
    v_mfma_f32_16x16x32_bf16 v[84:87], v[184:187], a[148:151], v[84:87]
    v_exp_f32 v154, v154
    v_mfma_f32_16x16x32_bf16 v[116:119], v[188:191], a[148:151], v[116:119]
    buffer_load_dwordx4 a[92:95], v213, s[32:35], s36 offen offset:3072 sc1
    v_mfma_f32_16x16x32_bf16 v[88:91], v[184:187], a[152:155], v[88:91]
    v_exp_f32 v155, v155
    v_mfma_f32_16x16x32_bf16 v[120:123], v[188:191], a[152:155], v[120:123]
    v_cvt_pk_bf16_f32 v181, v154, v155
    v_mfma_f32_16x16x32_bf16 v[92:95], v[184:187], a[156:159], v[92:95]
    v_exp_f32 v148, v148
    v_mfma_f32_16x16x32_bf16 v[124:127], v[188:191], a[156:159], v[124:127]
    buffer_load_dwordx4 a[128:131], v214, s[32:35], s36 offen offset:0 sc1
    v_mfma_f32_16x16x32_bf16 v[136:139], v[184:187], v[208:211], v[136:139]
    v_mfma_f32_16x16x32_bf16 v[140:143], v[188:191], v[208:211], v[140:143]
    s_cmp_lg_u64 s[44:45], 0
    s_cbranch_scc1 L_chk
    L_chkret:
    v_mfma_f32_16x16x32_bf16 v[160:163], a[96:99], a[32:35], v[200:203]
    v_exp_f32 v149, v149
    v_mfma_f32_16x16x32_bf16 v[160:163], a[100:103], a[36:39], v[160:163]
    v_cvt_pk_bf16_f32 v178, v148, v149
    s_ff1_i32_b64 s38, s[22:23]
    v_mfma_f32_16x16x32_bf16 v[160:163], a[104:107], a[40:43], v[160:163]
    v_exp_f32 v150, v150
    v_mfma_f32_16x16x32_bf16 v[160:163], a[108:111], a[44:47], v[160:163]
    buffer_load_dwordx4 a[132:135], v214, s[32:35], s36 offen offset:1024 sc1
    v_mfma_f32_16x16x32_bf16 v[168:171], a[96:99], a[48:51], v[204:207]
    v_exp_f32 v151, v151
    v_mfma_f32_16x16x32_bf16 v[168:171], a[100:103], a[52:55], v[168:171]
    v_cvt_pk_bf16_f32 v179, v150, v151
    s_bitset0_b64 s[22:23], s38
    v_mfma_f32_16x16x32_bf16 v[168:171], a[104:107], a[56:59], v[168:171]
    v_exp_f32 v156, v156
    v_mfma_f32_16x16x32_bf16 v[168:171], a[108:111], a[60:63], v[168:171]
    buffer_load_dwordx4 a[136:139], v214, s[32:35], s36 offen offset:2048 sc1
    v_mfma_f32_16x16x32_bf16 v[164:167], a[112:115], a[32:35], v[200:203]
    v_exp_f32 v157, v157
    v_mfma_f32_16x16x32_bf16 v[164:167], a[116:119], a[36:39], v[164:167]
    v_cvt_pk_bf16_f32 v182, v156, v157
    s_lshl_b32 s38, s38, 13
    v_mfma_f32_16x16x32_bf16 v[164:167], a[120:123], a[40:43], v[164:167]
    v_exp_f32 v158, v158
    v_mfma_f32_16x16x32_bf16 v[164:167], a[124:127], a[44:47], v[164:167]
    buffer_load_dwordx4 a[140:143], v214, s[32:35], s36 offen offset:3072 sc1
    v_mfma_f32_16x16x32_bf16 v[172:175], a[112:115], a[48:51], v[204:207]
    v_exp_f32 v159, v159
    v_mfma_f32_16x16x32_bf16 v[172:175], a[116:119], a[52:55], v[172:175]
    v_cvt_pk_bf16_f32 v183, v158, v159
    s_waitcnt vmcnt(16)
    v_mfma_f32_16x16x32_bf16 v[172:175], a[120:123], a[56:59], v[172:175]
    v_exp_f32 v160, v160
    v_mfma_f32_16x16x32_bf16 v[172:175], a[124:127], a[60:63], v[172:175]
    buffer_load_dwordx4 a[144:147], v215, s[32:35], s36 offen offset:0 sc1
    v_mfma_f32_16x16x32_bf16 v[0:3], v[176:179], a[160:163], v[0:3]
    v_exp_f32 v161, v161
    v_mfma_f32_16x16x32_bf16 v[32:35], v[180:183], a[160:163], v[32:35]
    v_cvt_pk_bf16_f32 v184, v160, v161
    v_mfma_f32_16x16x32_bf16 v[4:7], v[176:179], a[164:167], v[4:7]
    v_exp_f32 v162, v162
    v_mfma_f32_16x16x32_bf16 v[36:39], v[180:183], a[164:167], v[36:39]
    buffer_load_dwordx4 a[148:151], v215, s[32:35], s36 offen offset:1024 sc1
    v_mfma_f32_16x16x32_bf16 v[8:11], v[176:179], a[168:171], v[8:11]
    v_exp_f32 v163, v163
    v_mfma_f32_16x16x32_bf16 v[40:43], v[180:183], a[168:171], v[40:43]
    v_cvt_pk_bf16_f32 v185, v162, v163
    s_waitcnt vmcnt(14)
    v_mfma_f32_16x16x32_bf16 v[12:15], v[176:179], a[172:175], v[12:15]
    v_exp_f32 v168, v168
    v_mfma_f32_16x16x32_bf16 v[44:47], v[180:183], a[172:175], v[44:47]
    buffer_load_dwordx4 a[152:155], v215, s[32:35], s36 offen offset:2048 sc1
    v_mfma_f32_16x16x32_bf16 v[16:19], v[176:179], a[176:179], v[16:19]
    v_exp_f32 v169, v169
    v_mfma_f32_16x16x32_bf16 v[48:51], v[180:183], a[176:179], v[48:51]
    v_cvt_pk_bf16_f32 v188, v168, v169
    v_mfma_f32_16x16x32_bf16 v[20:23], v[176:179], a[180:183], v[20:23]
    v_exp_f32 v170, v170
    v_mfma_f32_16x16x32_bf16 v[52:55], v[180:183], a[180:183], v[52:55]
    buffer_load_dwordx4 a[156:159], v215, s[32:35], s36 offen offset:3072 sc1
    v_mfma_f32_16x16x32_bf16 v[24:27], v[176:179], a[184:187], v[24:27]
    v_exp_f32 v171, v171
    v_mfma_f32_16x16x32_bf16 v[56:59], v[180:183], a[184:187], v[56:59]
    v_cvt_pk_bf16_f32 v189, v170, v171
    s_and_b32 s36, s38, 0x3ffff
    v_mfma_f32_16x16x32_bf16 v[28:31], v[176:179], a[188:191], v[28:31]
    v_exp_f32 v164, v164
    v_mfma_f32_16x16x32_bf16 v[60:63], v[180:183], a[188:191], v[60:63]
    buffer_load_dwordx4 a[96:99], v212, s[32:35], s36 offen offset:0 sc1
    v_mfma_f32_16x16x32_bf16 v[128:131], v[176:179], v[208:211], v[128:131]
    s_cmp_eq_u64 s[22:23], 0
    v_mfma_f32_16x16x32_bf16 v[132:135], v[180:183], v[208:211], v[132:135]
    s_waitcnt vmcnt(13)
    s_cbranch_scc0 L_loop
L_tail:
    v_mfma_f32_16x16x32_bf16 v[144:147], a[64:67], a[0:3], v[192:195]
    v_exp_f32 v165, v165
    v_mfma_f32_16x16x32_bf16 v[144:147], a[68:71], a[4:7], v[144:147]
    v_cvt_pk_bf16_f32 v186, v164, v165
    buffer_load_dwordx4 a[100:103], v212, s[32:35], s36 offen offset:1024 sc1
    v_mfma_f32_16x16x32_bf16 v[144:147], a[72:75], a[8:11], v[144:147]
    v_exp_f32 v166, v166
    v_mfma_f32_16x16x32_bf16 v[144:147], a[76:79], a[12:15], v[144:147]
    buffer_load_dwordx4 a[104:107], v212, s[32:35], s36 offen offset:2048 sc1
    v_mfma_f32_16x16x32_bf16 v[152:155], a[64:67], a[16:19], v[196:199]
    v_exp_f32 v167, v167
    v_mfma_f32_16x16x32_bf16 v[152:155], a[68:71], a[20:23], v[152:155]
    v_cvt_pk_bf16_f32 v187, v166, v167
    buffer_load_dwordx4 a[108:111], v212, s[32:35], s36 offen offset:3072 sc1
    v_mfma_f32_16x16x32_bf16 v[152:155], a[72:75], a[24:27], v[152:155]
    v_exp_f32 v172, v172
    v_mfma_f32_16x16x32_bf16 v[152:155], a[76:79], a[28:31], v[152:155]
    buffer_load_dwordx4 a[112:115], v213, s[32:35], s36 offen offset:0 sc1
    s_waitcnt vmcnt(13)
    v_mfma_f32_16x16x32_bf16 v[148:151], a[80:83], a[0:3], v[192:195]
    v_exp_f32 v173, v173
    v_mfma_f32_16x16x32_bf16 v[148:151], a[84:87], a[4:7], v[148:151]
    v_cvt_pk_bf16_f32 v190, v172, v173
    buffer_load_dwordx4 a[116:119], v213, s[32:35], s36 offen offset:1024 sc1
    v_mfma_f32_16x16x32_bf16 v[148:151], a[88:91], a[8:11], v[148:151]
    v_exp_f32 v174, v174
    v_mfma_f32_16x16x32_bf16 v[148:151], a[92:95], a[12:15], v[148:151]
    buffer_load_dwordx4 a[120:123], v213, s[32:35], s36 offen offset:2048 sc1
    s_xor_b32 s52, s42, 3
    v_mfma_f32_16x16x32_bf16 v[156:159], a[80:83], a[16:19], v[196:199]
    v_exp_f32 v175, v175
    v_mfma_f32_16x16x32_bf16 v[156:159], a[84:87], a[20:23], v[156:159]
    v_cvt_pk_bf16_f32 v191, v174, v175
    buffer_load_dwordx4 a[124:127], v213, s[32:35], s36 offen offset:3072 sc1
    v_mfma_f32_16x16x32_bf16 v[156:159], a[88:91], a[24:27], v[156:159]
    v_exp_f32 v144, v144
    v_mfma_f32_16x16x32_bf16 v[156:159], a[92:95], a[28:31], v[156:159]
    s_mul_i32 s52, s52, 24576
    s_add_u32 s52, s52, 0
    v_mfma_f32_16x16x32_bf16 v[64:67], v[184:187], a[160:163], v[64:67]
    v_exp_f32 v145, v145
    v_mfma_f32_16x16x32_bf16 v[96:99], v[188:191], a[160:163], v[96:99]
    v_cvt_pk_bf16_f32 v176, v144, v145
    v_add_u32 v220, s52, v212
    v_mfma_f32_16x16x32_bf16 v[68:71], v[184:187], a[164:167], v[68:71]
    v_exp_f32 v146, v146
    v_mfma_f32_16x16x32_bf16 v[100:103], v[188:191], a[164:167], v[100:103]
    buffer_load_dwordx4 a[160:163], v214, s[32:35], s36 offen offset:0 sc1
    s_xor_b32 s52, s42, 2
    v_mfma_f32_16x16x32_bf16 v[72:75], v[184:187], a[168:171], v[72:75]
    v_exp_f32 v147, v147
    v_mfma_f32_16x16x32_bf16 v[104:107], v[188:191], a[168:171], v[104:107]
    v_cvt_pk_bf16_f32 v177, v146, v147
    s_mul_i32 s52, s52, 24576
    v_mfma_f32_16x16x32_bf16 v[76:79], v[184:187], a[172:175], v[76:79]
    v_exp_f32 v152, v152
    v_mfma_f32_16x16x32_bf16 v[108:111], v[188:191], a[172:175], v[108:111]
    buffer_load_dwordx4 a[164:167], v214, s[32:35], s36 offen offset:1024 sc1
    s_add_u32 s52, s52, 8192
    v_mfma_f32_16x16x32_bf16 v[80:83], v[184:187], a[176:179], v[80:83]
    v_exp_f32 v153, v153
    v_mfma_f32_16x16x32_bf16 v[112:115], v[188:191], a[176:179], v[112:115]
    v_cvt_pk_bf16_f32 v180, v152, v153
    v_add_u32 v221, s52, v212
    v_mfma_f32_16x16x32_bf16 v[84:87], v[184:187], a[180:183], v[84:87]
    v_exp_f32 v154, v154
    v_mfma_f32_16x16x32_bf16 v[116:119], v[188:191], a[180:183], v[116:119]
    buffer_load_dwordx4 a[168:171], v214, s[32:35], s36 offen offset:2048 sc1
    s_xor_b32 s52, s42, 1
    v_mfma_f32_16x16x32_bf16 v[88:91], v[184:187], a[184:187], v[88:91]
    v_exp_f32 v155, v155
    v_mfma_f32_16x16x32_bf16 v[120:123], v[188:191], a[184:187], v[120:123]
    v_cvt_pk_bf16_f32 v181, v154, v155
    s_mul_i32 s52, s52, 24576
    v_mfma_f32_16x16x32_bf16 v[92:95], v[184:187], a[188:191], v[92:95]
    v_exp_f32 v148, v148
    v_mfma_f32_16x16x32_bf16 v[124:127], v[188:191], a[188:191], v[124:127]
    buffer_load_dwordx4 a[172:175], v214, s[32:35], s36 offen offset:3072 sc1
    s_add_u32 s52, s52, 16384
    v_mfma_f32_16x16x32_bf16 v[136:139], v[184:187], v[208:211], v[136:139]
    v_add_u32 v222, s52, v212
    s_lshl_b32 s53, s42, 8
    v_mfma_f32_16x16x32_bf16 v[140:143], v[188:191], v[208:211], v[140:143]
    s_add_u32 s53, s53, 115712
    s_waitcnt vmcnt(8)
    v_mfma_f32_16x16x32_bf16 v[160:163], a[96:99], a[0:3], v[192:195]
    v_exp_f32 v149, v149
    v_mfma_f32_16x16x32_bf16 v[160:163], a[100:103], a[4:7], v[160:163]
    v_cvt_pk_bf16_f32 v178, v148, v149
    v_lshlrev_b32 v223, 4, v218
    v_mfma_f32_16x16x32_bf16 v[160:163], a[104:107], a[8:11], v[160:163]
    v_exp_f32 v150, v150
    v_mfma_f32_16x16x32_bf16 v[160:163], a[108:111], a[12:15], v[160:163]
    buffer_load_dwordx4 a[176:179], v215, s[32:35], s36 offen offset:0 sc1
    s_mov_b32 s60, 0x00010001
    v_mfma_f32_16x16x32_bf16 v[168:171], a[96:99], a[16:19], v[196:199]
    v_exp_f32 v151, v151
    v_mfma_f32_16x16x32_bf16 v[168:171], a[100:103], a[20:23], v[168:171]
    v_cvt_pk_bf16_f32 v179, v150, v151
    s_mov_b32 s61, 0x00010001
    v_mfma_f32_16x16x32_bf16 v[168:171], a[104:107], a[24:27], v[168:171]
    v_exp_f32 v156, v156
    v_mfma_f32_16x16x32_bf16 v[168:171], a[108:111], a[28:31], v[168:171]
    buffer_load_dwordx4 a[180:183], v215, s[32:35], s36 offen offset:1024 sc1
    s_waitcnt vmcnt(6)
    v_mfma_f32_16x16x32_bf16 v[164:167], a[112:115], a[0:3], v[192:195]
    v_exp_f32 v157, v157
    v_mfma_f32_16x16x32_bf16 v[164:167], a[116:119], a[4:7], v[164:167]
    v_cvt_pk_bf16_f32 v182, v156, v157
    s_xor_b32 s52, s42, 3
    v_mfma_f32_16x16x32_bf16 v[164:167], a[120:123], a[8:11], v[164:167]
    v_exp_f32 v158, v158
    v_mfma_f32_16x16x32_bf16 v[164:167], a[124:127], a[12:15], v[164:167]
    buffer_load_dwordx4 a[184:187], v215, s[32:35], s36 offen offset:2048 sc1
    s_lshl_b32 s52, s52, 6
    v_mfma_f32_16x16x32_bf16 v[172:175], a[112:115], a[16:19], v[196:199]
    v_exp_f32 v159, v159
    v_mfma_f32_16x16x32_bf16 v[172:175], a[116:119], a[20:23], v[172:175]
    v_cvt_pk_bf16_f32 v183, v158, v159
    s_add_u32 s52, s52, s53
    v_mfma_f32_16x16x32_bf16 v[172:175], a[120:123], a[24:27], v[172:175]
    v_exp_f32 v160, v160
    v_mfma_f32_16x16x32_bf16 v[172:175], a[124:127], a[28:31], v[172:175]
    buffer_load_dwordx4 a[188:191], v215, s[32:35], s36 offen offset:3072 sc1
    s_waitcnt vmcnt(20)
    v_mfma_f32_16x16x32_bf16 v[0:3], v[176:179], a[128:131], v[0:3]
    v_exp_f32 v161, v161
    v_mfma_f32_16x16x32_bf16 v[32:35], v[180:183], a[128:131], v[32:35]
    v_cvt_pk_bf16_f32 v184, v160, v161
    v_add_u32 v224, s52, v223
    v_mfma_f32_16x16x32_bf16 v[4:7], v[176:179], a[132:135], v[4:7]
    v_exp_f32 v162, v162
    v_mfma_f32_16x16x32_bf16 v[36:39], v[180:183], a[132:135], v[36:39]
    s_xor_b32 s52, s42, 2
    s_lshl_b32 s52, s52, 6
    v_mfma_f32_16x16x32_bf16 v[8:11], v[176:179], a[136:139], v[8:11]
    v_exp_f32 v163, v163
    v_mfma_f32_16x16x32_bf16 v[40:43], v[180:183], a[136:139], v[40:43]
    v_cvt_pk_bf16_f32 v185, v162, v163
    s_add_u32 s52, s52, s53
    v_mfma_f32_16x16x32_bf16 v[12:15], v[176:179], a[140:143], v[12:15]
    v_exp_f32 v168, v168
    v_mfma_f32_16x16x32_bf16 v[44:47], v[180:183], a[140:143], v[44:47]
    v_add_u32 v225, s52, v223
    s_waitcnt vmcnt(16)
    v_mfma_f32_16x16x32_bf16 v[16:19], v[176:179], a[144:147], v[16:19]
    v_exp_f32 v169, v169
    v_mfma_f32_16x16x32_bf16 v[48:51], v[180:183], a[144:147], v[48:51]
    v_cvt_pk_bf16_f32 v188, v168, v169
    s_xor_b32 s52, s42, 1
    v_mfma_f32_16x16x32_bf16 v[20:23], v[176:179], a[148:151], v[20:23]
    v_exp_f32 v170, v170
    v_mfma_f32_16x16x32_bf16 v[52:55], v[180:183], a[148:151], v[52:55]
    s_lshl_b32 s52, s52, 6
    s_add_u32 s52, s52, s53
    v_mfma_f32_16x16x32_bf16 v[24:27], v[176:179], a[152:155], v[24:27]
    v_exp_f32 v171, v171
    v_mfma_f32_16x16x32_bf16 v[56:59], v[180:183], a[152:155], v[56:59]
    v_cvt_pk_bf16_f32 v189, v170, v171
    v_add_u32 v226, s52, v223
    v_mfma_f32_16x16x32_bf16 v[28:31], v[176:179], a[156:159], v[28:31]
    v_exp_f32 v164, v164
    v_mfma_f32_16x16x32_bf16 v[60:63], v[180:183], a[156:159], v[60:63]
    s_xor_b32 s52, s42, 0
    s_lshl_b32 s52, s52, 6
    v_mfma_f32_16x16x32_bf16 v[128:131], v[176:179], v[208:211], v[128:131]
    s_add_u32 s52, s52, s53
    v_add_u32 v227, s52, v223
    v_mfma_f32_16x16x32_bf16 v[132:135], v[180:183], v[208:211], v[132:135]
    s_mul_i32 s52, s42, 24576
    v_add_u32 v228, s52, v212
    v_mfma_f32_16x16x32_bf16 v[144:147], a[64:67], a[32:35], v[200:203]
    v_exp_f32 v165, v165
    v_mfma_f32_16x16x32_bf16 v[144:147], a[68:71], a[36:39], v[144:147]
    v_cvt_pk_bf16_f32 v186, v164, v165
    v_lshlrev_b32 v229, 2, v216
    v_mfma_f32_16x16x32_bf16 v[144:147], a[72:75], a[40:43], v[144:147]
    v_exp_f32 v166, v166
    v_mfma_f32_16x16x32_bf16 v[144:147], a[76:79], a[44:47], v[144:147]
    v_add_u32 v229, 115712, v229
    s_lshl_b32 s52, s42, 6
    v_mfma_f32_16x16x32_bf16 v[152:155], a[64:67], a[48:51], v[204:207]
    v_exp_f32 v167, v167
    v_mfma_f32_16x16x32_bf16 v[152:155], a[68:71], a[52:55], v[152:155]
    v_cvt_pk_bf16_f32 v187, v166, v167
    s_add_u32 s52, s52, 115712
    v_mfma_f32_16x16x32_bf16 v[152:155], a[72:75], a[56:59], v[152:155]
    v_exp_f32 v172, v172
    v_mfma_f32_16x16x32_bf16 v[152:155], a[76:79], a[60:63], v[152:155]
    v_add_u32 v230, s52, v223
    s_lshl_b32 s52, s46, 7
    v_mfma_f32_16x16x32_bf16 v[148:151], a[80:83], a[32:35], v[200:203]
    v_exp_f32 v173, v173
    v_mfma_f32_16x16x32_bf16 v[148:151], a[84:87], a[36:39], v[148:151]
    v_cvt_pk_bf16_f32 v190, v172, v173
    s_lshl_b32 s53, s47, 2
    v_mfma_f32_16x16x32_bf16 v[148:151], a[88:91], a[40:43], v[148:151]
    v_exp_f32 v174, v174
    v_mfma_f32_16x16x32_bf16 v[148:151], a[92:95], a[44:47], v[148:151]
    s_add_u32 s52, s52, s53
    s_add_u32 s52, s52, s42
    v_mfma_f32_16x16x32_bf16 v[156:159], a[80:83], a[48:51], v[204:207]
    v_exp_f32 v175, v175
    v_mfma_f32_16x16x32_bf16 v[156:159], a[84:87], a[52:55], v[156:159]
    v_cvt_pk_bf16_f32 v191, v174, v175
    s_lshl_b32 s52, s52, 12
    v_mfma_f32_16x16x32_bf16 v[156:159], a[88:91], a[56:59], v[156:159]
    v_exp_f32 v144, v144
    v_mfma_f32_16x16x32_bf16 v[156:159], a[92:95], a[60:63], v[156:159]
    v_lshlrev_b32 v231, 3, v217
    s_waitcnt vmcnt(4)
    v_mfma_f32_16x16x32_bf16 v[0:3], v[184:187], a[160:163], v[0:3]
    v_exp_f32 v145, v145
    v_mfma_f32_16x16x32_bf16 v[32:35], v[188:191], a[160:163], v[32:35]
    v_cvt_pk_bf16_f32 v176, v144, v145
    v_lshl_add_u32 v231, v218, 10, v231
    v_mfma_f32_16x16x32_bf16 v[4:7], v[184:187], a[164:167], v[4:7]
    v_exp_f32 v146, v146
    v_mfma_f32_16x16x32_bf16 v[36:39], v[188:191], a[164:167], v[36:39]
    v_add_u32 v231, s52, v231
    v_mfma_f32_16x16x32_bf16 v[8:11], v[184:187], a[168:171], v[8:11]
    v_exp_f32 v147, v147
    v_mfma_f32_16x16x32_bf16 v[40:43], v[188:191], a[168:171], v[40:43]
    v_cvt_pk_bf16_f32 v177, v146, v147
    ds_write_b128 v220, v[0:3] offset:0
    v_mfma_f32_16x16x32_bf16 v[12:15], v[184:187], a[172:175], v[12:15]
    v_exp_f32 v152, v152
    v_mfma_f32_16x16x32_bf16 v[44:47], v[188:191], a[172:175], v[44:47]
    s_waitcnt vmcnt(0)
    v_mfma_f32_16x16x32_bf16 v[16:19], v[184:187], a[176:179], v[16:19]
    v_exp_f32 v153, v153
    v_mfma_f32_16x16x32_bf16 v[48:51], v[188:191], a[176:179], v[48:51]
    v_cvt_pk_bf16_f32 v180, v152, v153
    ds_write_b128 v221, v[32:35] offset:0
    v_mfma_f32_16x16x32_bf16 v[20:23], v[184:187], a[180:183], v[20:23]
    v_exp_f32 v154, v154
    v_mfma_f32_16x16x32_bf16 v[52:55], v[188:191], a[180:183], v[52:55]
    ds_write_b128 v220, v[4:7] offset:1024
    v_mfma_f32_16x16x32_bf16 v[24:27], v[184:187], a[184:187], v[24:27]
    v_exp_f32 v155, v155
    v_mfma_f32_16x16x32_bf16 v[56:59], v[188:191], a[184:187], v[56:59]
    v_cvt_pk_bf16_f32 v181, v154, v155
    v_mfma_f32_16x16x32_bf16 v[28:31], v[184:187], a[188:191], v[28:31]
    v_exp_f32 v148, v148
    v_mfma_f32_16x16x32_bf16 v[60:63], v[188:191], a[188:191], v[60:63]
    ds_write_b128 v221, v[36:39] offset:1024
    v_mfma_f32_16x16x32_bf16 v[128:131], v[184:187], v[208:211], v[128:131]
    v_mfma_f32_16x16x32_bf16 v[132:135], v[188:191], v[208:211], v[132:135]
    ds_write_b128 v220, v[8:11] offset:2048
    v_mfma_f32_16x16x32_bf16 v[160:163], a[96:99], a[32:35], v[200:203]
    v_exp_f32 v149, v149
    v_mfma_f32_16x16x32_bf16 v[160:163], a[100:103], a[36:39], v[160:163]
    v_cvt_pk_bf16_f32 v178, v148, v149
    v_mfma_f32_16x16x32_bf16 v[160:163], a[104:107], a[40:43], v[160:163]
    v_exp_f32 v150, v150
    v_mfma_f32_16x16x32_bf16 v[160:163], a[108:111], a[44:47], v[160:163]
    ds_write_b128 v221, v[40:43] offset:2048
    v_mfma_f32_16x16x32_bf16 v[164:167], a[112:115], a[32:35], v[200:203]
    v_exp_f32 v151, v151
    v_mfma_f32_16x16x32_bf16 v[164:167], a[116:119], a[36:39], v[164:167]
    v_cvt_pk_bf16_f32 v179, v150, v151
    ds_write_b128 v220, v[12:15] offset:3072
    v_mfma_f32_16x16x32_bf16 v[164:167], a[120:123], a[40:43], v[164:167]
    v_exp_f32 v156, v156
    v_mfma_f32_16x16x32_bf16 v[164:167], a[124:127], a[44:47], v[164:167]
    v_mfma_f32_16x16x32_bf16 v[168:171], a[96:99], a[48:51], v[204:207]
    v_exp_f32 v157, v157
    v_mfma_f32_16x16x32_bf16 v[168:171], a[100:103], a[52:55], v[168:171]
    v_cvt_pk_bf16_f32 v182, v156, v157
    ds_write_b128 v221, v[44:47] offset:3072
    v_mfma_f32_16x16x32_bf16 v[168:171], a[104:107], a[56:59], v[168:171]
    v_exp_f32 v158, v158
    v_mfma_f32_16x16x32_bf16 v[168:171], a[108:111], a[60:63], v[168:171]
    ds_write_b128 v220, v[16:19] offset:4096
    v_mfma_f32_16x16x32_bf16 v[172:175], a[112:115], a[48:51], v[204:207]
    v_exp_f32 v159, v159
    v_mfma_f32_16x16x32_bf16 v[172:175], a[116:119], a[52:55], v[172:175]
    v_cvt_pk_bf16_f32 v183, v158, v159
    v_mfma_f32_16x16x32_bf16 v[172:175], a[120:123], a[56:59], v[172:175]
    v_exp_f32 v160, v160
    v_mfma_f32_16x16x32_bf16 v[172:175], a[124:127], a[60:63], v[172:175]
    v_exp_f32 v161, v161
    v_mfma_f32_16x16x32_bf16 v[64:67], v[176:179], a[128:131], v[64:67]
    v_cvt_pk_bf16_f32 v184, v160, v161
    v_exp_f32 v162, v162
    v_mfma_f32_16x16x32_bf16 v[68:71], v[176:179], a[132:135], v[68:71]
    v_exp_f32 v163, v163
    v_mfma_f32_16x16x32_bf16 v[72:75], v[176:179], a[136:139], v[72:75]
    v_cvt_pk_bf16_f32 v185, v162, v163
    ds_write_b128 v221, v[48:51] offset:4096
    v_mfma_f32_16x16x32_bf16 v[76:79], v[176:179], a[140:143], v[76:79]
    v_exp_f32 v164, v164
    v_mfma_f32_16x16x32_bf16 v[80:83], v[176:179], a[144:147], v[80:83]
    v_exp_f32 v165, v165
    v_mfma_f32_16x16x32_bf16 v[84:87], v[176:179], a[148:151], v[84:87]
    v_cvt_pk_bf16_f32 v186, v164, v165
    v_exp_f32 v166, v166
    v_mfma_f32_16x16x32_bf16 v[88:91], v[176:179], a[152:155], v[88:91]
    v_exp_f32 v167, v167
    v_mfma_f32_16x16x32_bf16 v[92:95], v[176:179], a[156:159], v[92:95]
    v_cvt_pk_bf16_f32 v187, v166, v167
    ds_write_b128 v220, v[20:23] offset:5120
    v_mfma_f32_16x16x32_bf16 v[136:139], v[176:179], v[208:211], v[136:139]
    ds_write_b128 v221, v[52:55] offset:5120
    v_mfma_f32_16x16x32_bf16 v[64:67], v[184:187], a[160:163], v[64:67]
    ds_write_b128 v220, v[24:27] offset:6144
    v_mfma_f32_16x16x32_bf16 v[68:71], v[184:187], a[164:167], v[68:71]
    v_exp_f32 v168, v168
    v_mfma_f32_16x16x32_bf16 v[72:75], v[184:187], a[168:171], v[72:75]
    v_exp_f32 v169, v169
    v_mfma_f32_16x16x32_bf16 v[76:79], v[184:187], a[172:175], v[76:79]
    v_cvt_pk_bf16_f32 v188, v168, v169
    ds_write_b128 v221, v[56:59] offset:6144
    v_mfma_f32_16x16x32_bf16 v[80:83], v[184:187], a[176:179], v[80:83]
    v_exp_f32 v170, v170
    v_mfma_f32_16x16x32_bf16 v[84:87], v[184:187], a[180:183], v[84:87]
    v_exp_f32 v171, v171
    v_mfma_f32_16x16x32_bf16 v[88:91], v[184:187], a[184:187], v[88:91]
    v_cvt_pk_bf16_f32 v189, v170, v171
    ds_write_b128 v220, v[28:31] offset:7168
    v_mfma_f32_16x16x32_bf16 v[92:95], v[184:187], a[188:191], v[92:95]
    v_exp_f32 v172, v172
    v_mfma_f32_16x16x32_bf16 v[136:139], v[184:187], v[208:211], v[136:139]
    v_exp_f32 v173, v173
    v_mfma_f32_16x16x32_bf16 v[96:99], v[180:183], a[128:131], v[96:99]
    v_cvt_pk_bf16_f32 v190, v172, v173
    ds_write_b128 v221, v[60:63] offset:7168
    v_mfma_f32_16x16x32_bf16 v[100:103], v[180:183], a[132:135], v[100:103]
    v_exp_f32 v174, v174
    v_mfma_f32_16x16x32_bf16 v[104:107], v[180:183], a[136:139], v[104:107]
    v_exp_f32 v175, v175
    v_mfma_f32_16x16x32_bf16 v[108:111], v[180:183], a[140:143], v[108:111]
    v_cvt_pk_bf16_f32 v191, v174, v175
    ds_write_b128 v222, v[64:67] offset:0
    v_mfma_f32_16x16x32_bf16 v[112:115], v[180:183], a[144:147], v[112:115]
    ds_write_b128 v222, v[68:71] offset:1024
    v_mfma_f32_16x16x32_bf16 v[116:119], v[180:183], a[148:151], v[116:119]
    v_mfma_f32_16x16x32_bf16 v[120:123], v[180:183], a[152:155], v[120:123]
    v_mfma_f32_16x16x32_bf16 v[124:127], v[180:183], a[156:159], v[124:127]
    ds_write_b128 v222, v[72:75] offset:2048
    v_mfma_f32_16x16x32_bf16 v[140:143], v[180:183], v[208:211], v[140:143]
    v_mfma_f32_16x16x32_bf16 v[96:99], v[188:191], a[160:163], v[96:99]
    v_mfma_f32_16x16x32_bf16 v[100:103], v[188:191], a[164:167], v[100:103]
    ds_write_b128 v222, v[76:79] offset:3072
    v_mfma_f32_16x16x32_bf16 v[104:107], v[188:191], a[168:171], v[104:107]
    v_mfma_f32_16x16x32_bf16 v[108:111], v[188:191], a[172:175], v[108:111]
    v_mfma_f32_16x16x32_bf16 v[112:115], v[188:191], a[176:179], v[112:115]
    ds_write_b128 v222, v[80:83] offset:4096
    v_mfma_f32_16x16x32_bf16 v[116:119], v[188:191], a[180:183], v[116:119]
    v_mfma_f32_16x16x32_bf16 v[120:123], v[188:191], a[184:187], v[120:123]
    v_mfma_f32_16x16x32_bf16 v[124:127], v[188:191], a[188:191], v[124:127]
    ds_write_b128 v222, v[84:87] offset:5120
    v_mfma_f32_16x16x32_bf16 v[140:143], v[188:191], v[208:211], v[140:143]
    ds_write_b128 v222, v[88:91] offset:6144
    ds_write_b128 v222, v[92:95] offset:7168
    s_nop 2
    s_mov_b64 exec, s[60:61]
    ds_write_b128 v224, v[128:131]
    ds_write_b128 v225, v[132:135]
    ds_write_b128 v226, v[136:139]
    ds_write_b128 v227, v[140:143]
    s_mov_b64 exec, -1
    s_waitcnt lgkmcnt(0)
    s_barrier
    ds_read_b128 v[128:131], v230 offset:0
    ds_read_b128 v[132:135], v230 offset:256
    ds_read_b128 v[136:139], v230 offset:512
    ds_read_b128 v[140:143], v230 offset:768
    ds_read_b128 v[0:3], v228 offset:0
    ds_read_b128 v[4:7], v228 offset:1024
    ds_read_b128 v[8:11], v228 offset:2048
    ds_read_b128 v[12:15], v228 offset:3072
    ds_read_b128 v[32:35], v228 offset:8192
    ds_read_b128 v[36:39], v228 offset:9216
    ds_read_b128 v[40:43], v228 offset:10240
    ds_read_b128 v[44:47], v228 offset:11264
    ds_read_b128 v[64:67], v228 offset:16384
    ds_read_b128 v[68:71], v228 offset:17408
    s_waitcnt lgkmcnt(10)
    ds_read_b128 v[72:75], v228 offset:18432
    ds_read_b128 v[76:79], v228 offset:19456
    ds_read_b128 v[16:19], v228 offset:4096
    ds_read_b128 v[20:23], v228 offset:5120
    v_pk_add_f32 v[128:129], v[128:129], v[132:133]
    v_pk_add_f32 v[136:137], v[136:137], v[140:141]
    v_pk_add_f32 v[130:131], v[130:131], v[134:135]
    v_pk_add_f32 v[138:139], v[138:139], v[142:143]
    v_pk_add_f32 v[128:129], v[128:129], v[136:137]
    v_pk_add_f32 v[130:131], v[130:131], v[138:139]
    v_rcp_f32 v128, v128
    v_rcp_f32 v129, v129
    v_rcp_f32 v130, v130
    v_rcp_f32 v131, v131
    s_waitcnt lgkmcnt(10)
    ds_read_b128 v[24:27], v228 offset:6144
    ds_read_b128 v[28:31], v228 offset:7168
    ds_read_b128 v[48:51], v228 offset:12288
    ds_read_b128 v[52:55], v228 offset:13312
    v_pk_add_f32 v[96:97], v[96:97], v[0:1]
    v_pk_add_f32 v[98:99], v[98:99], v[2:3]
    v_pk_add_f32 v[100:101], v[100:101], v[4:5]
    v_pk_add_f32 v[102:103], v[102:103], v[6:7]
    v_pk_add_f32 v[104:105], v[104:105], v[8:9]
    v_pk_add_f32 v[106:107], v[106:107], v[10:11]
    v_pk_add_f32 v[108:109], v[108:109], v[12:13]
    v_pk_add_f32 v[110:111], v[110:111], v[14:15]
    s_waitcnt lgkmcnt(10)
    ds_read_b128 v[56:59], v228 offset:14336
    ds_read_b128 v[60:63], v228 offset:15360
    ds_read_b128 v[80:83], v228 offset:20480
    ds_read_b128 v[84:87], v228 offset:21504
    v_pk_add_f32 v[96:97], v[96:97], v[32:33]
    v_pk_add_f32 v[98:99], v[98:99], v[34:35]
    v_pk_add_f32 v[100:101], v[100:101], v[36:37]
    v_pk_add_f32 v[102:103], v[102:103], v[38:39]
    v_pk_add_f32 v[104:105], v[104:105], v[40:41]
    v_pk_add_f32 v[106:107], v[106:107], v[42:43]
    v_pk_add_f32 v[108:109], v[108:109], v[44:45]
    v_pk_add_f32 v[110:111], v[110:111], v[46:47]
    s_waitcnt lgkmcnt(10)
    ds_read_b128 v[88:91], v228 offset:22528
    ds_read_b128 v[92:95], v228 offset:23552
    ds_read_b32 v176, v229 offset:0
    ds_read_b32 v177, v229 offset:256
    v_pk_add_f32 v[96:97], v[96:97], v[64:65]
    v_pk_add_f32 v[100:101], v[100:101], v[68:69]
    v_pk_add_f32 v[104:105], v[104:105], v[72:73]
    v_pk_add_f32 v[108:109], v[108:109], v[76:77]
    v_pk_mul_f32 v[96:97], v[96:97], v[128:129]
    v_pk_mul_f32 v[100:101], v[100:101], v[128:129]
    v_pk_mul_f32 v[104:105], v[104:105], v[128:129]
    v_pk_mul_f32 v[108:109], v[108:109], v[128:129]
    v_cvt_pk_bf16_f32 v144, v96, v100
    v_cvt_pk_bf16_f32 v145, v104, v108
    global_store_dwordx2 v231, v[144:145], s[26:27] offset:0 sc1 nt
    v_cvt_pk_bf16_f32 v146, v97, v101
    v_cvt_pk_bf16_f32 v147, v105, v109
    global_store_dwordx2 v231, v[146:147], s[26:27] offset:256 sc1 nt
    v_pk_add_f32 v[98:99], v[98:99], v[66:67]
    v_pk_add_f32 v[102:103], v[102:103], v[70:71]
    v_pk_add_f32 v[106:107], v[106:107], v[74:75]
    v_pk_add_f32 v[110:111], v[110:111], v[78:79]
    v_pk_mul_f32 v[98:99], v[98:99], v[130:131]
    v_pk_mul_f32 v[102:103], v[102:103], v[130:131]
    v_pk_mul_f32 v[106:107], v[106:107], v[130:131]
    v_pk_mul_f32 v[110:111], v[110:111], v[130:131]
    v_cvt_pk_bf16_f32 v148, v98, v102
    v_cvt_pk_bf16_f32 v149, v106, v110
    global_store_dwordx2 v231, v[148:149], s[26:27] offset:512 sc1 nt
    v_cvt_pk_bf16_f32 v150, v99, v103
    v_cvt_pk_bf16_f32 v151, v107, v111
    global_store_dwordx2 v231, v[150:151], s[26:27] offset:768 sc1 nt
    s_waitcnt lgkmcnt(10)
    ds_read_b32 v178, v229 offset:512
    ds_read_b32 v179, v229 offset:768
    v_pk_add_f32 v[112:113], v[112:113], v[16:17]
    v_pk_add_f32 v[114:115], v[114:115], v[18:19]
    v_pk_add_f32 v[116:117], v[116:117], v[20:21]
    v_pk_add_f32 v[118:119], v[118:119], v[22:23]
    v_pk_add_f32 v[120:121], v[120:121], v[24:25]
    v_pk_add_f32 v[122:123], v[122:123], v[26:27]
    v_pk_add_f32 v[124:125], v[124:125], v[28:29]
    v_pk_add_f32 v[126:127], v[126:127], v[30:31]
    s_waitcnt lgkmcnt(8)
    v_pk_add_f32 v[112:113], v[112:113], v[48:49]
    v_pk_add_f32 v[114:115], v[114:115], v[50:51]
    v_pk_add_f32 v[116:117], v[116:117], v[52:53]
    v_pk_add_f32 v[118:119], v[118:119], v[54:55]
    v_pk_add_f32 v[120:121], v[120:121], v[56:57]
    v_pk_add_f32 v[122:123], v[122:123], v[58:59]
    v_pk_add_f32 v[124:125], v[124:125], v[60:61]
    v_pk_add_f32 v[126:127], v[126:127], v[62:63]
    s_waitcnt lgkmcnt(4)
    v_pk_add_f32 v[112:113], v[112:113], v[80:81]
    v_pk_add_f32 v[116:117], v[116:117], v[84:85]
    v_pk_add_f32 v[120:121], v[120:121], v[88:89]
    v_pk_add_f32 v[124:125], v[124:125], v[92:93]
    v_pk_mul_f32 v[112:113], v[112:113], v[128:129]
    v_pk_mul_f32 v[116:117], v[116:117], v[128:129]
    v_pk_mul_f32 v[120:121], v[120:121], v[128:129]
    v_pk_mul_f32 v[124:125], v[124:125], v[128:129]
    v_cvt_pk_bf16_f32 v152, v112, v116
    v_cvt_pk_bf16_f32 v153, v120, v124
    global_store_dwordx2 v231, v[152:153], s[26:27] offset:128 sc1 nt
    v_cvt_pk_bf16_f32 v154, v113, v117
    v_cvt_pk_bf16_f32 v155, v121, v125
    global_store_dwordx2 v231, v[154:155], s[26:27] offset:384 sc1 nt
    v_pk_add_f32 v[114:115], v[114:115], v[82:83]
    v_pk_add_f32 v[118:119], v[118:119], v[86:87]
    v_pk_add_f32 v[122:123], v[122:123], v[90:91]
    v_pk_add_f32 v[126:127], v[126:127], v[94:95]
    v_pk_mul_f32 v[114:115], v[114:115], v[130:131]
    v_pk_mul_f32 v[118:119], v[118:119], v[130:131]
    v_pk_mul_f32 v[122:123], v[122:123], v[130:131]
    v_pk_mul_f32 v[126:127], v[126:127], v[130:131]
    v_cvt_pk_bf16_f32 v156, v114, v118
    v_cvt_pk_bf16_f32 v157, v122, v126
    global_store_dwordx2 v231, v[156:157], s[26:27] offset:640 sc1 nt
    v_cvt_pk_bf16_f32 v158, v115, v119
    v_cvt_pk_bf16_f32 v159, v123, v127
    global_store_dwordx2 v231, v[158:159], s[26:27] offset:896 sc1 nt
    s_waitcnt lgkmcnt(0)
    v_add_f32 v176, v176, v177
    v_add_f32 v178, v178, v179
    s_mov_b32 s52, 0x30800000
    v_add_f32 v176, v176, v178
    s_mov_b32 s53, 0x4e800000
    v_cmp_nle_f32 vcc, s52, v176
    v_cmp_nge_f32 s[60:61], s53, v176
    s_nop 1
    s_or_b64 vcc, vcc, s[60:61]
    s_cbranch_scc0 L_good
    s_cmp_eq_u32 s41, 0
    s_cbranch_scc1 L_fallback
L_good:
L_end:
    s_endpgm
L_chk:
    s_waitcnt vmcnt(10)
    s_mov_b32 s24, 400
L_chk2:
    v_cmp_gt_u64 vcc, s[56:57], v[236:237]
    v_cmp_lt_u64 s[60:61], s[58:59], v[236:237]
    s_nop 0
    s_nor_b64 s[18:19], vcc, s[60:61]
    s_lshr_b64 s[20:21], s[18:19], 1
    s_and_b64 s[18:19], s[18:19], s[44:45]
    s_and_b64 s[18:19], s[18:19], s[20:21]
    s_or_b64 s[22:23], s[22:23], s[18:19]
    s_bcnt1_i32_b64 s20, s[22:23]
    s_xor_b64 s[44:45], s[44:45], s[18:19]
    s_cbranch_scc0 L_chkret
    global_load_dwordx2 v[236:237], v235, s[30:31] sc1
    s_cmp_ge_u32 s20, 2
    s_cbranch_scc1 L_chkret
    s_waitcnt vmcnt(0)
    s_sub_u32 s24, s24, 1
    s_cmp_lg_u32 s24, 0
    s_cbranch_scc1 L_chk2
    s_nop 15
    s_branch L_selfprep
L_selfprep:
    s_waitcnt vmcnt(0) lgkmcnt(0)
    s_lshl_b32 s48, s100, 1
    s_mov_b32 s22, 0x55555555
    s_mov_b32 s23, 0
    s_mov_b64 s[44:45], 0
    s_mov_b32 s3, 0
L_sp_loop:
    s_lshl_b32 s52, s46, 7
    s_add_u32 s52, s52, s48
    s_lshl_b32 s53, s52, 13
    s_add_u32 s53, s53, 0x1000
    v_lshlrev_b32 v236, 4, v217
    v_lshl_add_u32 v220, v218, 9, v236
    v_add_u32 v220, s53, v220
    s_lshl_b32 s53, s52, 7
    v_lshl_add_u32 v222, v216, 1, s53
    s_lshr_b32 s53, s52, 1
    s_and_b32 s54, s52, 1
    s_lshl_b32 s52, s53, 14
    v_lshl_add_u32 v223, v218, 11, v236
    v_add_u32 v223, s52, v223
    s_lshl_b32 s40, s54, 8
    v_add_u32 v223, s40, v223
    v_add_u32 v224, 0x2000, v223
    s_andn2_b32 s55, s53, 63
    s_bfe_u32 s52, s53, 0x40002
    s_or_b32 s55, s55, s52
    s_and_b32 s52, s53, 3
    s_lshl4_add_u32 s55, s52, s55
    s_lshl_b32 s52, s55, 14
    s_lshl_b32 s40, s54, 12
    s_add_u32 s52, s52, s40
    v_add_u32 v226, s52, v213
    s_lshl_b32 s53, s53, 8
    s_lshl_b32 s54, s54, 2
    s_add_u32 s53, s53, s54
    v_and_b32 v237, 31, v216
    v_lshrrev_b32 v238, 5, v216
    v_lshlrev_b32 v238, 1, v238
    v_lshl_add_u32 v225, v237, 3, v238
    v_add_u32 v225, s53, v225
    s_lshl_b32 s53, s48, 12
    v_lshlrev_b32 v221, 3, v217
    v_lshl_add_u32 v221, v218, 8, v221
    v_add_u32 v221, s53, v221
    global_load_dwordx4 v[0:3], v220, s[6:7] offset:-4096 nt
    global_load_dwordx4 v[4:7], v220, s[6:7] offset:-3840 nt
    global_load_dwordx4 v[8:11], v220, s[6:7] offset:-2048 nt
    global_load_dwordx4 v[12:15], v220, s[6:7] offset:-1792 nt
    global_load_dwordx4 v[16:19], v220, s[6:7] offset:0 nt
    global_load_dwordx4 v[20:23], v220, s[6:7] offset:256 nt
    global_load_dwordx4 v[24:27], v220, s[6:7] offset:2048 nt
    global_load_dwordx4 v[28:31], v220, s[6:7] offset:2304 nt
    global_load_ushort v144, v222, s[8:9] nt
    global_load_ushort v145, v222, s[10:11] nt
    global_load_ushort v146, v225, s[14:15] nt
    global_load_ushort v147, v225, s[16:17] nt
    global_load_dwordx4 v[64:67], v223, s[12:13] offset:0 nt
    global_load_dwordx4 v[68:71], v223, s[12:13] offset:512 nt
    global_load_dwordx4 v[72:75], v223, s[12:13] offset:1024 nt
    global_load_dwordx4 v[76:79], v223, s[12:13] offset:1536 nt
    global_load_dwordx4 v[80:83], v224, s[12:13] offset:0 nt
    global_load_dwordx4 v[84:87], v224, s[12:13] offset:512 nt
    global_load_dwordx4 v[88:91], v224, s[12:13] offset:1024 nt
    global_load_dwordx4 v[92:95], v224, s[12:13] offset:1536 nt
    s_lshl_b32 s52, s48, 4
    v_add_u32 v180, s52, v218
    v_cvt_f32_u32 v180, v180
    v_mul_f32 v181, v180, v242
    v_mul_f32 v182, v180, v243
    v_mul_f32 v183, v180, v244
    v_mul_f32 v184, v180, v245
    v_mul_f32 v32, s62, v181
    v_mul_f32 v33, s62, v182
    v_mul_f32 v34, s62, v183
    v_mul_f32 v35, s62, v184
    v_fma_f32 v48, v181, s62, -v32
    v_fma_f32 v49, v182, s62, -v33
    v_fma_f32 v50, v183, s62, -v34
    v_fma_f32 v51, v184, s62, -v35
    v_fma_f32 v48, v181, s63, v48
    v_fma_f32 v49, v182, s63, v49
    v_fma_f32 v50, v183, s63, v50
    v_fma_f32 v51, v184, s63, v51
    v_fract_f32 v32, v32
    v_fract_f32 v33, v33
    v_fract_f32 v34, v34
    v_fract_f32 v35, v35
    v_add_f32 v181, v32, v48
    v_add_f32 v182, v33, v49
    v_add_f32 v183, v34, v50
    v_add_f32 v184, v35, v51
    v_cos_f32 v32, v181
    v_sin_f32 v48, v181
    v_cos_f32 v33, v182
    v_sin_f32 v49, v182
    v_cos_f32 v34, v183
    v_sin_f32 v50, v183
    v_cos_f32 v35, v184
    v_sin_f32 v51, v184
    v_add_f32 v180, 4.0, v180
    v_cvt_pk_bf16_f32 v48, v32, v48
    v_cvt_pk_bf16_f32 v49, v33, v49
    v_cvt_pk_bf16_f32 v50, v34, v50
    v_cvt_pk_bf16_f32 v51, v35, v51
    v_lshlrev_b32 v32, 16, v48
    v_and_b32 v48, s49, v48
    v_lshlrev_b32 v33, 16, v49
    v_and_b32 v49, s49, v49
    v_lshlrev_b32 v34, 16, v50
    v_and_b32 v50, s49, v50
    v_lshlrev_b32 v35, 16, v51
    v_and_b32 v51, s49, v51
    v_mul_f32 v181, v180, v242
    v_mul_f32 v182, v180, v243
    v_mul_f32 v183, v180, v244
    v_mul_f32 v184, v180, v245
    v_mul_f32 v36, s62, v181
    v_mul_f32 v37, s62, v182
    v_mul_f32 v38, s62, v183
    v_mul_f32 v39, s62, v184
    v_fma_f32 v52, v181, s62, -v36
    v_fma_f32 v53, v182, s62, -v37
    v_fma_f32 v54, v183, s62, -v38
    v_fma_f32 v55, v184, s62, -v39
    v_fma_f32 v52, v181, s63, v52
    v_fma_f32 v53, v182, s63, v53
    v_fma_f32 v54, v183, s63, v54
    v_fma_f32 v55, v184, s63, v55
    v_fract_f32 v36, v36
    v_fract_f32 v37, v37
    v_fract_f32 v38, v38
    v_fract_f32 v39, v39
    v_add_f32 v181, v36, v52
    v_add_f32 v182, v37, v53
    v_add_f32 v183, v38, v54
    v_add_f32 v184, v39, v55
    v_cos_f32 v36, v181
    v_sin_f32 v52, v181
    v_cos_f32 v37, v182
    v_sin_f32 v53, v182
    v_cos_f32 v38, v183
    v_sin_f32 v54, v183
    v_cos_f32 v39, v184
    v_sin_f32 v55, v184
    v_add_f32 v180, 4.0, v180
    v_cvt_pk_bf16_f32 v52, v36, v52
    v_cvt_pk_bf16_f32 v53, v37, v53
    v_cvt_pk_bf16_f32 v54, v38, v54
    v_cvt_pk_bf16_f32 v55, v39, v55
    v_lshlrev_b32 v36, 16, v52
    v_and_b32 v52, s49, v52
    v_lshlrev_b32 v37, 16, v53
    v_and_b32 v53, s49, v53
    v_lshlrev_b32 v38, 16, v54
    v_and_b32 v54, s49, v54
    v_lshlrev_b32 v39, 16, v55
    v_and_b32 v55, s49, v55
    v_mul_f32 v181, v180, v242
    v_mul_f32 v182, v180, v243
    v_mul_f32 v183, v180, v244
    v_mul_f32 v184, v180, v245
    v_mul_f32 v40, s62, v181
    v_mul_f32 v41, s62, v182
    v_mul_f32 v42, s62, v183
    v_mul_f32 v43, s62, v184
    v_fma_f32 v56, v181, s62, -v40
    v_fma_f32 v57, v182, s62, -v41
    v_fma_f32 v58, v183, s62, -v42
    v_fma_f32 v59, v184, s62, -v43
    v_fma_f32 v56, v181, s63, v56
    v_fma_f32 v57, v182, s63, v57
    v_fma_f32 v58, v183, s63, v58
    v_fma_f32 v59, v184, s63, v59
    v_fract_f32 v40, v40
    v_fract_f32 v41, v41
    v_fract_f32 v42, v42
    v_fract_f32 v43, v43
    v_add_f32 v181, v40, v56
    v_add_f32 v182, v41, v57
    v_add_f32 v183, v42, v58
    v_add_f32 v184, v43, v59
    v_cos_f32 v40, v181
    v_sin_f32 v56, v181
    v_cos_f32 v41, v182
    v_sin_f32 v57, v182
    v_cos_f32 v42, v183
    v_sin_f32 v58, v183
    v_cos_f32 v43, v184
    v_sin_f32 v59, v184
    v_add_f32 v180, 4.0, v180
    v_cvt_pk_bf16_f32 v56, v40, v56
    v_cvt_pk_bf16_f32 v57, v41, v57
    v_cvt_pk_bf16_f32 v58, v42, v58
    v_cvt_pk_bf16_f32 v59, v43, v59
    v_lshlrev_b32 v40, 16, v56
    v_and_b32 v56, s49, v56
    v_lshlrev_b32 v41, 16, v57
    v_and_b32 v57, s49, v57
    v_lshlrev_b32 v42, 16, v58
    v_and_b32 v58, s49, v58
    v_lshlrev_b32 v43, 16, v59
    v_and_b32 v59, s49, v59
    v_mul_f32 v181, v180, v242
    v_mul_f32 v182, v180, v243
    v_mul_f32 v183, v180, v244
    v_mul_f32 v184, v180, v245
    v_mul_f32 v44, s62, v181
    v_mul_f32 v45, s62, v182
    v_mul_f32 v46, s62, v183
    v_mul_f32 v47, s62, v184
    v_fma_f32 v60, v181, s62, -v44
    v_fma_f32 v61, v182, s62, -v45
    v_fma_f32 v62, v183, s62, -v46
    v_fma_f32 v63, v184, s62, -v47
    v_fma_f32 v60, v181, s63, v60
    v_fma_f32 v61, v182, s63, v61
    v_fma_f32 v62, v183, s63, v62
    v_fma_f32 v63, v184, s63, v63
    v_fract_f32 v44, v44
    v_fract_f32 v45, v45
    v_fract_f32 v46, v46
    v_fract_f32 v47, v47
    v_add_f32 v181, v44, v60
    v_add_f32 v182, v45, v61
    v_add_f32 v183, v46, v62
    v_add_f32 v184, v47, v63
    v_cos_f32 v44, v181
    v_sin_f32 v60, v181
    v_cos_f32 v45, v182
    v_sin_f32 v61, v182
    v_cos_f32 v46, v183
    v_sin_f32 v62, v183
    v_cos_f32 v47, v184
    v_sin_f32 v63, v184
    s_nop 0
    v_cvt_pk_bf16_f32 v60, v44, v60
    v_cvt_pk_bf16_f32 v61, v45, v61
    v_cvt_pk_bf16_f32 v62, v46, v62
    v_cvt_pk_bf16_f32 v63, v47, v63
    v_lshlrev_b32 v44, 16, v60
    v_and_b32 v60, s49, v60
    v_lshlrev_b32 v45, 16, v61
    v_and_b32 v61, s49, v61
    v_lshlrev_b32 v46, 16, v62
    v_and_b32 v62, s49, v62
    v_lshlrev_b32 v47, 16, v63
    v_and_b32 v63, s49, v63
    s_waitcnt vmcnt(8)
    v_lshlrev_b32 v144, 16, v144
    v_lshlrev_b32 v145, 16, v145
    v_lshlrev_b32 v146, 16, v146
    v_lshlrev_b32 v147, 16, v147
    v_mul_f32 v145, v145, v144
    v_mul_f32 v147, v147, v146
    ds_write_b64 v229, v[144:145] offset:4352
    ds_write_b32 v231, v146 offset:4864
    ds_write_b32 v231, v147 offset:5120
    v_cvt_f32_i32 v0, v0
    v_cvt_f32_i32 v1, v1
    v_cvt_f32_i32 v2, v2
    v_cvt_f32_i32 v3, v3
    v_cvt_f32_i32 v4, v4
    v_cvt_f32_i32 v5, v5
    v_cvt_f32_i32 v6, v6
    v_cvt_f32_i32 v7, v7
    v_cvt_f32_i32 v8, v8
    v_cvt_f32_i32 v9, v9
    v_cvt_f32_i32 v10, v10
    v_cvt_f32_i32 v11, v11
    s_waitcnt lgkmcnt(0)
    ds_read_b128 v[148:151], v230 offset:4352
    ds_read_b128 v[152:155], v230 offset:4480
    ds_read_b128 v[156:159], v230 offset:4608
    ds_read_b128 v[160:163], v230 offset:4736
    ds_read_b128 v[164:167], v232 offset:4864
    ds_read_b128 v[168:171], v232 offset:4928
    ds_read_b128 v[172:175], v232 offset:5120
    ds_read_b128 v[176:179], v232 offset:5184
    v_cvt_f32_i32 v12, v12
    v_cvt_f32_i32 v13, v13
    v_cvt_f32_i32 v14, v14
    v_cvt_f32_i32 v15, v15
    v_cvt_f32_i32 v16, v16
    v_cvt_f32_i32 v17, v17
    v_cvt_f32_i32 v18, v18
    v_cvt_f32_i32 v19, v19
    v_cvt_f32_i32 v20, v20
    v_cvt_f32_i32 v21, v21
    v_cvt_f32_i32 v22, v22
    v_cvt_f32_i32 v23, v23
    v_cvt_f32_i32 v24, v24
    v_cvt_f32_i32 v25, v25
    v_cvt_f32_i32 v26, v26
    v_cvt_f32_i32 v27, v27
    v_cvt_f32_i32 v28, v28
    v_cvt_f32_i32 v29, v29
    v_cvt_f32_i32 v30, v30
    v_cvt_f32_i32 v31, v31
    s_waitcnt lgkmcnt(0)
    v_fma_f32 v0, v0, v148, -v149
    v_fma_f32 v1, v1, v148, -v149
    v_fma_f32 v2, v2, v148, -v149
    v_fma_f32 v3, v3, v148, -v149
    v_fma_f32 v4, v4, v150, -v151
    v_fma_f32 v5, v5, v150, -v151
    v_fma_f32 v6, v6, v150, -v151
    v_fma_f32 v7, v7, v150, -v151
    v_mul_f32 v180, v0, v32
    v_mul_f32 v184, v4, v32
    v_mul_f32 v181, v1, v33
    v_mul_f32 v185, v5, v33
    v_mul_f32 v182, v2, v34
    v_mul_f32 v186, v6, v34
    v_mul_f32 v183, v3, v35
    v_mul_f32 v187, v7, v35
    v_fma_f32 v180, -v4, v48, v180
    v_fma_f32 v184, v0, v48, v184
    v_fma_f32 v181, -v5, v49, v181
    v_fma_f32 v185, v1, v49, v185
    v_fma_f32 v182, -v6, v50, v182
    v_fma_f32 v186, v2, v50, v186
    v_fma_f32 v183, -v7, v51, v183
    v_fma_f32 v187, v3, v51, v187
    v_cvt_pk_bf16_f32 v188, v180, v181
    v_cvt_pk_bf16_f32 v189, v182, v183
    v_cvt_pk_bf16_f32 v190, v184, v185
    v_cvt_pk_bf16_f32 v191, v186, v187
    ds_write_b128 v227, v[188:191] offset:0
    v_fma_f32 v8, v8, v152, -v153
    v_fma_f32 v9, v9, v152, -v153
    v_fma_f32 v10, v10, v152, -v153
    v_fma_f32 v11, v11, v152, -v153
    v_fma_f32 v12, v12, v154, -v155
    v_fma_f32 v13, v13, v154, -v155
    v_fma_f32 v14, v14, v154, -v155
    v_fma_f32 v15, v15, v154, -v155
    v_mul_f32 v180, v8, v36
    v_mul_f32 v184, v12, v36
    v_mul_f32 v181, v9, v37
    v_mul_f32 v185, v13, v37
    v_mul_f32 v182, v10, v38
    v_mul_f32 v186, v14, v38
    v_mul_f32 v183, v11, v39
    v_mul_f32 v187, v15, v39
    v_fma_f32 v180, -v12, v52, v180
    v_fma_f32 v184, v8, v52, v184
    v_fma_f32 v181, -v13, v53, v181
    v_fma_f32 v185, v9, v53, v185
    v_fma_f32 v182, -v14, v54, v182
    v_fma_f32 v186, v10, v54, v186
    v_fma_f32 v183, -v15, v55, v183
    v_fma_f32 v187, v11, v55, v187
    v_cvt_pk_bf16_f32 v192, v180, v181
    v_cvt_pk_bf16_f32 v193, v182, v183
    v_cvt_pk_bf16_f32 v194, v184, v185
    v_cvt_pk_bf16_f32 v195, v186, v187
    ds_write_b128 v227, v[192:195] offset:64
    v_fma_f32 v16, v16, v156, -v157
    v_fma_f32 v17, v17, v156, -v157
    v_fma_f32 v18, v18, v156, -v157
    v_fma_f32 v19, v19, v156, -v157
    v_fma_f32 v20, v20, v158, -v159
    v_fma_f32 v21, v21, v158, -v159
    v_fma_f32 v22, v22, v158, -v159
    v_fma_f32 v23, v23, v158, -v159
    v_mul_f32 v180, v16, v40
    v_mul_f32 v184, v20, v40
    v_mul_f32 v181, v17, v41
    v_mul_f32 v185, v21, v41
    v_mul_f32 v182, v18, v42
    v_mul_f32 v186, v22, v42
    v_mul_f32 v183, v19, v43
    v_mul_f32 v187, v23, v43
    v_fma_f32 v180, -v20, v56, v180
    v_fma_f32 v184, v16, v56, v184
    v_fma_f32 v181, -v21, v57, v181
    v_fma_f32 v185, v17, v57, v185
    v_fma_f32 v182, -v22, v58, v182
    v_fma_f32 v186, v18, v58, v186
    v_fma_f32 v183, -v23, v59, v183
    v_fma_f32 v187, v19, v59, v187
    v_cvt_pk_bf16_f32 v196, v180, v181
    v_cvt_pk_bf16_f32 v197, v182, v183
    v_cvt_pk_bf16_f32 v198, v184, v185
    v_cvt_pk_bf16_f32 v199, v186, v187
    ds_write_b128 v227, v[196:199] offset:128
    v_fma_f32 v24, v24, v160, -v161
    v_fma_f32 v25, v25, v160, -v161
    v_fma_f32 v26, v26, v160, -v161
    v_fma_f32 v27, v27, v160, -v161
    v_fma_f32 v28, v28, v162, -v163
    v_fma_f32 v29, v29, v162, -v163
    v_fma_f32 v30, v30, v162, -v163
    v_fma_f32 v31, v31, v162, -v163
    v_mul_f32 v180, v24, v44
    v_mul_f32 v184, v28, v44
    v_mul_f32 v181, v25, v45
    v_mul_f32 v185, v29, v45
    v_mul_f32 v182, v26, v46
    v_mul_f32 v186, v30, v46
    v_mul_f32 v183, v27, v47
    v_mul_f32 v187, v31, v47
    v_fma_f32 v180, -v28, v60, v180
    v_fma_f32 v184, v24, v60, v184
    v_fma_f32 v181, -v29, v61, v181
    v_fma_f32 v185, v25, v61, v185
    v_fma_f32 v182, -v30, v62, v182
    v_fma_f32 v186, v26, v62, v186
    v_fma_f32 v183, -v31, v63, v183
    v_fma_f32 v187, v27, v63, v187
    v_cvt_pk_bf16_f32 v200, v180, v181
    v_cvt_pk_bf16_f32 v201, v182, v183
    v_cvt_pk_bf16_f32 v202, v184, v185
    v_cvt_pk_bf16_f32 v203, v186, v187
    ds_write_b128 v227, v[200:203] offset:192
    s_waitcnt lgkmcnt(0)
    ds_read_b128 v[0:3], v228 offset:0
    ds_read_b128 v[4:7], v228 offset:1088
    ds_read_b128 v[8:11], v228 offset:2176
    ds_read_b128 v[12:15], v228 offset:3264
    s_waitcnt lgkmcnt(3)
    global_store_dwordx4 v226, v[0:3], s[30:31] offset:-4096 sc1
    s_waitcnt lgkmcnt(2)
    global_store_dwordx4 v226, v[4:7], s[30:31] offset:-3072 sc1
    s_waitcnt lgkmcnt(1)
    global_store_dwordx4 v226, v[8:11], s[30:31] offset:-2048 sc1
    s_waitcnt lgkmcnt(0)
    global_store_dwordx4 v226, v[12:15], s[30:31] offset:-1024 sc1
    v_add_u32 v226, 0x2000, v226
    s_waitcnt vmcnt(4)
    v_cvt_f32_i32 v64, v64
    v_cvt_f32_i32 v68, v68
    v_cvt_f32_i32 v72, v72
    v_cvt_f32_i32 v76, v76
    v_cvt_f32_i32 v80, v80
    v_cvt_f32_i32 v84, v84
    v_cvt_f32_i32 v88, v88
    v_cvt_f32_i32 v92, v92
    v_fma_f32 v64, v64, v164, -v172
    v_fma_f32 v68, v68, v165, -v173
    v_fma_f32 v72, v72, v166, -v174
    v_fma_f32 v76, v76, v167, -v175
    v_fma_f32 v80, v80, v168, -v176
    v_fma_f32 v84, v84, v169, -v177
    v_fma_f32 v88, v88, v170, -v178
    v_fma_f32 v92, v92, v171, -v179
    v_cvt_pk_bf16_f32 v32, v64, v68
    v_cvt_pk_bf16_f32 v33, v72, v76
    v_cvt_pk_bf16_f32 v34, v80, v84
    v_cvt_pk_bf16_f32 v35, v88, v92
    global_store_dwordx4 v226, v[32:35], s[30:31] offset:-4096 sc1
    v_cvt_f32_i32 v65, v65
    v_cvt_f32_i32 v69, v69
    v_cvt_f32_i32 v73, v73
    v_cvt_f32_i32 v77, v77
    v_cvt_f32_i32 v81, v81
    v_cvt_f32_i32 v85, v85
    v_cvt_f32_i32 v89, v89
    v_cvt_f32_i32 v93, v93
    v_fma_f32 v65, v65, v164, -v172
    v_fma_f32 v69, v69, v165, -v173
    v_fma_f32 v73, v73, v166, -v174
    v_fma_f32 v77, v77, v167, -v175
    v_fma_f32 v81, v81, v168, -v176
    v_fma_f32 v85, v85, v169, -v177
    v_fma_f32 v89, v89, v170, -v178
    v_fma_f32 v93, v93, v171, -v179
    v_cvt_pk_bf16_f32 v36, v65, v69
    v_cvt_pk_bf16_f32 v37, v73, v77
    v_cvt_pk_bf16_f32 v38, v81, v85
    v_cvt_pk_bf16_f32 v39, v89, v93
    global_store_dwordx4 v226, v[36:39], s[30:31] offset:-3072 sc1
    v_cvt_f32_i32 v66, v66
    v_cvt_f32_i32 v70, v70
    v_cvt_f32_i32 v74, v74
    v_cvt_f32_i32 v78, v78
    v_cvt_f32_i32 v82, v82
    v_cvt_f32_i32 v86, v86
    v_cvt_f32_i32 v90, v90
    v_cvt_f32_i32 v94, v94
    v_fma_f32 v66, v66, v164, -v172
    v_fma_f32 v70, v70, v165, -v173
    v_fma_f32 v74, v74, v166, -v174
    v_fma_f32 v78, v78, v167, -v175
    v_fma_f32 v82, v82, v168, -v176
    v_fma_f32 v86, v86, v169, -v177
    v_fma_f32 v90, v90, v170, -v178
    v_fma_f32 v94, v94, v171, -v179
    v_cvt_pk_bf16_f32 v40, v66, v70
    v_cvt_pk_bf16_f32 v41, v74, v78
    v_cvt_pk_bf16_f32 v42, v82, v86
    v_cvt_pk_bf16_f32 v43, v90, v94
    global_store_dwordx4 v226, v[40:43], s[30:31] offset:-2048 sc1
    v_cvt_f32_i32 v67, v67
    v_cvt_f32_i32 v71, v71
    v_cvt_f32_i32 v75, v75
    v_cvt_f32_i32 v79, v79
    v_cvt_f32_i32 v83, v83
    v_cvt_f32_i32 v87, v87
    v_cvt_f32_i32 v91, v91
    v_cvt_f32_i32 v95, v95
    v_fma_f32 v67, v67, v164, -v172
    v_fma_f32 v71, v71, v165, -v173
    v_fma_f32 v75, v75, v166, -v174
    v_fma_f32 v79, v79, v167, -v175
    v_fma_f32 v83, v83, v168, -v176
    v_fma_f32 v87, v87, v169, -v177
    v_fma_f32 v91, v91, v170, -v178
    v_fma_f32 v95, v95, v171, -v179
    v_cvt_pk_bf16_f32 v44, v67, v71
    v_cvt_pk_bf16_f32 v45, v75, v79
    v_cvt_pk_bf16_f32 v46, v83, v87
    v_cvt_pk_bf16_f32 v47, v91, v95
    global_store_dwordx4 v226, v[44:47], s[30:31] offset:-1024 sc1
    s_waitcnt vmcnt(0)
    s_bitcmp1_b32 s48, 0
    s_cselect_b32 s52, 7, 1
    s_add_u32 s48, s48, s52
    s_cmp_lt_u32 s48, 128
    s_cbranch_scc1 L_sp_loop
    v_mov_b32 v192, 0
    v_mov_b32 v193, 0
    v_mov_b32 v194, 0
    v_mov_b32 v195, 0
    v_mov_b32 v196, 0
    v_mov_b32 v197, 0
    v_mov_b32 v198, 0
    v_mov_b32 v199, 0
    v_mov_b32 v200, 0
    v_mov_b32 v201, 0
    v_mov_b32 v202, 0
    v_mov_b32 v203, 0
    v_mov_b32 v204, 0
    v_mov_b32 v205, 0
    v_mov_b32 v206, 0
    v_mov_b32 v207, 0
    s_branch L_ready
L_fallback:
    s_mov_b32 s41, 1
    s_mov_b32 s3, 0
    s_mov_b32 s22, 0x55555555
    s_mov_b32 s23, 0
    s_mov_b64 s[44:45], 0
    s_waitcnt vmcnt(0) lgkmcnt(0)
    v_mov_b32 v192, 0xff800000
    v_mov_b32 v196, 0xff800000
    v_mov_b32 v200, 0xff800000
    v_mov_b32 v204, 0xff800000
    s_mov_b32 s36, 0
    s_mov_b32 s40, 16
L_maxloop:
    buffer_load_dwordx4 a[64:67], v212, s[32:35], s36 offen offset:0 sc1
    buffer_load_dwordx4 a[68:71], v212, s[32:35], s36 offen offset:1024 sc1
    buffer_load_dwordx4 a[72:75], v212, s[32:35], s36 offen offset:2048 sc1
    buffer_load_dwordx4 a[76:79], v212, s[32:35], s36 offen offset:3072 sc1
    buffer_load_dwordx4 a[80:83], v213, s[32:35], s36 offen offset:0 sc1
    buffer_load_dwordx4 a[84:87], v213, s[32:35], s36 offen offset:1024 sc1
    buffer_load_dwordx4 a[88:91], v213, s[32:35], s36 offen offset:2048 sc1
    buffer_load_dwordx4 a[92:95], v213, s[32:35], s36 offen offset:3072 sc1
    s_waitcnt vmcnt(0)
    v_mfma_f32_16x16x32_bf16 v[144:147], a[64:67], a[0:3], 0
    v_mfma_f32_16x16x32_bf16 v[144:147], a[68:71], a[4:7], v[144:147]
    v_mfma_f32_16x16x32_bf16 v[144:147], a[72:75], a[8:11], v[144:147]
    v_mfma_f32_16x16x32_bf16 v[144:147], a[76:79], a[12:15], v[144:147]
    v_mfma_f32_16x16x32_bf16 v[148:151], a[80:83], a[0:3], 0
    v_mfma_f32_16x16x32_bf16 v[148:151], a[84:87], a[4:7], v[148:151]
    v_mfma_f32_16x16x32_bf16 v[148:151], a[88:91], a[8:11], v[148:151]
    v_mfma_f32_16x16x32_bf16 v[148:151], a[92:95], a[12:15], v[148:151]
    v_mfma_f32_16x16x32_bf16 v[152:155], a[64:67], a[16:19], 0
    v_mfma_f32_16x16x32_bf16 v[152:155], a[68:71], a[20:23], v[152:155]
    v_mfma_f32_16x16x32_bf16 v[152:155], a[72:75], a[24:27], v[152:155]
    v_mfma_f32_16x16x32_bf16 v[152:155], a[76:79], a[28:31], v[152:155]
    v_mfma_f32_16x16x32_bf16 v[156:159], a[80:83], a[16:19], 0
    v_mfma_f32_16x16x32_bf16 v[156:159], a[84:87], a[20:23], v[156:159]
    v_mfma_f32_16x16x32_bf16 v[156:159], a[88:91], a[24:27], v[156:159]
    v_mfma_f32_16x16x32_bf16 v[156:159], a[92:95], a[28:31], v[156:159]
    v_mfma_f32_16x16x32_bf16 v[160:163], a[64:67], a[32:35], 0
    v_mfma_f32_16x16x32_bf16 v[160:163], a[68:71], a[36:39], v[160:163]
    v_mfma_f32_16x16x32_bf16 v[160:163], a[72:75], a[40:43], v[160:163]
    v_mfma_f32_16x16x32_bf16 v[160:163], a[76:79], a[44:47], v[160:163]
    v_mfma_f32_16x16x32_bf16 v[164:167], a[80:83], a[32:35], 0
    v_mfma_f32_16x16x32_bf16 v[164:167], a[84:87], a[36:39], v[164:167]
    v_mfma_f32_16x16x32_bf16 v[164:167], a[88:91], a[40:43], v[164:167]
    v_mfma_f32_16x16x32_bf16 v[164:167], a[92:95], a[44:47], v[164:167]
    v_mfma_f32_16x16x32_bf16 v[168:171], a[64:67], a[48:51], 0
    v_mfma_f32_16x16x32_bf16 v[168:171], a[68:71], a[52:55], v[168:171]
    v_mfma_f32_16x16x32_bf16 v[168:171], a[72:75], a[56:59], v[168:171]
    v_mfma_f32_16x16x32_bf16 v[168:171], a[76:79], a[60:63], v[168:171]
    v_mfma_f32_16x16x32_bf16 v[172:175], a[80:83], a[48:51], 0
    v_mfma_f32_16x16x32_bf16 v[172:175], a[84:87], a[52:55], v[172:175]
    v_mfma_f32_16x16x32_bf16 v[172:175], a[88:91], a[56:59], v[172:175]
    v_mfma_f32_16x16x32_bf16 v[172:175], a[92:95], a[60:63], v[172:175]
    s_nop 15
    v_max3_f32 v192, v192, v144, v145
    v_max3_f32 v192, v192, v146, v147
    v_max3_f32 v192, v192, v148, v149
    v_max3_f32 v192, v192, v150, v151
    v_max3_f32 v196, v196, v152, v153
    v_max3_f32 v196, v196, v154, v155
    v_max3_f32 v196, v196, v156, v157
    v_max3_f32 v196, v196, v158, v159
    v_max3_f32 v200, v200, v160, v161
    v_max3_f32 v200, v200, v162, v163
    v_max3_f32 v200, v200, v164, v165
    v_max3_f32 v200, v200, v166, v167
    v_max3_f32 v204, v204, v168, v169
    v_max3_f32 v204, v204, v170, v171
    v_max3_f32 v204, v204, v172, v173
    v_max3_f32 v204, v204, v174, v175
    s_add_u32 s36, s36, 0x4000
    s_sub_u32 s40, s40, 1
    s_cmp_lg_u32 s40, 0
    s_cbranch_scc1 L_maxloop
    v_mov_b32 v193, v192
    v_mov_b32 v197, v196
    v_mov_b32 v201, v200
    v_mov_b32 v205, v204
    s_nop 1
    v_permlane16_swap_b32 v192, v193
    v_permlane16_swap_b32 v196, v197
    v_permlane16_swap_b32 v200, v201
    v_permlane16_swap_b32 v204, v205
    s_nop 1
    v_max_f32 v192, v192, v193
    v_max_f32 v196, v196, v197
    v_max_f32 v200, v200, v201
    v_max_f32 v204, v204, v205
    v_mov_b32 v193, v192
    v_mov_b32 v197, v196
    v_mov_b32 v201, v200
    v_mov_b32 v205, v204
    s_nop 1
    v_permlane32_swap_b32 v192, v193
    v_permlane32_swap_b32 v196, v197
    v_permlane32_swap_b32 v200, v201
    v_permlane32_swap_b32 v204, v205
    s_nop 1
    v_max_f32 v192, v192, v193
    v_max_f32 v196, v196, v197
    v_max_f32 v200, v200, v201
    v_max_f32 v204, v204, v205
    s_lshl_b32 s53, s42, 8
    s_xor_b32 s52, s42, 3
    s_lshl_b32 s52, s52, 6
    s_add_u32 s52, s52, 116736
    v_lshl_add_u32 v224, v217, 2, s52
    v_add_u32 v232, s53, v224
    ds_write_b32 v232, v192
    s_xor_b32 s52, s42, 2
    s_lshl_b32 s52, s52, 6
    s_add_u32 s52, s52, 116736
    v_lshl_add_u32 v225, v217, 2, s52
    v_add_u32 v232, s53, v225
    ds_write_b32 v232, v196
    s_xor_b32 s52, s42, 1
    s_lshl_b32 s52, s52, 6
    s_add_u32 s52, s52, 116736
    v_lshl_add_u32 v226, v217, 2, s52
    v_add_u32 v232, s53, v226
    ds_write_b32 v232, v200
    s_xor_b32 s52, s42, 0
    s_lshl_b32 s52, s52, 6
    s_add_u32 s52, s52, 116736
    v_lshl_add_u32 v227, v217, 2, s52
    v_add_u32 v232, s53, v227
    ds_write_b32 v232, v204
    s_waitcnt lgkmcnt(0)
    s_barrier
    ds_read_b32 v192, v224 offset:0
    ds_read_b32 v193, v224 offset:256
    ds_read_b32 v194, v224 offset:512
    ds_read_b32 v195, v224 offset:768
    s_waitcnt lgkmcnt(0)
    v_max3_f32 v192, v192, v193, v194
    v_max_f32 v192, v192, v195
    v_sub_f32 v192, 0, v192
    v_mov_b32 v193, v192
    v_mov_b32 v194, v192
    v_mov_b32 v195, v192
    ds_read_b32 v196, v225 offset:0
    ds_read_b32 v197, v225 offset:256
    ds_read_b32 v198, v225 offset:512
    ds_read_b32 v199, v225 offset:768
    s_waitcnt lgkmcnt(0)
    v_max3_f32 v196, v196, v197, v198
    v_max_f32 v196, v196, v199
    v_sub_f32 v196, 0, v196
    v_mov_b32 v197, v196
    v_mov_b32 v198, v196
    v_mov_b32 v199, v196
    ds_read_b32 v200, v226 offset:0
    ds_read_b32 v201, v226 offset:256
    ds_read_b32 v202, v226 offset:512
    ds_read_b32 v203, v226 offset:768
    s_waitcnt lgkmcnt(0)
    v_max3_f32 v200, v200, v201, v202
    v_max_f32 v200, v200, v203
    v_sub_f32 v200, 0, v200
    v_mov_b32 v201, v200
    v_mov_b32 v202, v200
    v_mov_b32 v203, v200
    ds_read_b32 v204, v227 offset:0
    ds_read_b32 v205, v227 offset:256
    ds_read_b32 v206, v227 offset:512
    ds_read_b32 v207, v227 offset:768
    s_waitcnt lgkmcnt(0)
    v_max3_f32 v204, v204, v205, v206
    v_max_f32 v204, v204, v207
    v_sub_f32 v204, 0, v204
    v_mov_b32 v205, v204
    v_mov_b32 v206, v204
    v_mov_b32 v207, v204
    s_branch L_ready
.section .rodata,"a"
.p2align 6
.amdhsa_kernel standalone__kv_cache_quant_pre_rope_vs_post_rope__prompt_kernel
  .amdhsa_next_free_vgpr 512
  .amdhsa_next_free_sgpr 102
  .amdhsa_accum_offset 256
  .amdhsa_group_segment_fixed_size 0
  .amdhsa_kernarg_size 112
  .amdhsa_user_sgpr_count 2
  .amdhsa_user_sgpr_kernarg_segment_ptr 1
  .amdhsa_system_sgpr_workgroup_id_x 1
  .amdhsa_float_denorm_mode_32 3
.end_amdhsa_kernel
```
